```python
import torch

def _softmax(x, axis=-1):
    return torch.softmax(x, dim=axis)

def _gelu(x):
    return torch.nn.functional.gelu(x, approximate='tanh')

def _silu(x):
    return torch.nn.functional.silu(x)

def _sigmoid(x):
    return torch.sigmoid(x)

def _layernorm(x, axis=-1, eps=1e-05):
    m = x.mean(dim=axis, keepdim=True)
    v = x.var(dim=axis, keepdim=True, unbiased=False)
    return (x - m) / torch.sqrt(v + eps)

def _scatter_add(tgt, idx, src, axis=0):
    return tgt.clone().index_add_(axis, idx, src)

def _segment_sum(src, seg, n):
    out = torch.zeros((n,) + src.shape[1:], dtype=src.dtype)
    return out.index_add_(0, seg, src)

def _pad(x, pw):
    flat = tuple((v for pair in reversed(pw) for v in pair))
    return torch.nn.functional.pad(x, flat)
kernel_name = 'standalone__window_attn_davit__vision'

def setup_inputs():

    _w = lambda a: (lambda t: t.to(torch.bfloat16) if t.is_floating_point() else t)(torch.as_tensor(a))
    HW = 224
    C0 = 192
    ws = 7
    nh = 4
    H = W = max(HW // ws * ws, ws)
    C = max(C0 // nh * nh, nh)
    k = 3
    return {'x': _w((lambda *s: torch.randn(*s, dtype=torch.bfloat16) * 1.6)(1, H, W, C)), 'dw_pe': _w((lambda *s: torch.randn(*s, dtype=torch.bfloat16) * 1.6)(k, k, C) * 0.1), 'w_qkv': _w((lambda *s: torch.randn(*s, dtype=torch.bfloat16) * 1.6)(C, 3 * C) * C ** (-0.5)), 'w_o': _w((lambda *s: torch.randn(*s, dtype=torch.bfloat16) * 0.4)(C, C) * C ** (-0.5))}

def reference(x, dw_pe, w_qkv, w_o):
    B, H, W, C = x.shape
    ws = 7
    nh = 4
    dh = C // nh
    kk = dw_pe.shape[0]
    pad = kk // 2
    xp = _pad(x, ((0, 0), (pad, pad), (pad, pad), (0, 0)))
    pe = torch.zeros_like(x)
    for i in range(kk):
        for j in range(kk):
            pe = pe + xp[:, i:i + H, j:j + W, :] * dw_pe[i, j][None, None, None, :]
    x0 = x + pe
    h = _layernorm(x0, axis=-1)
    hw = h.reshape(B, H // ws, ws, W // ws, ws, C)
    hw = (lambda x, *d: x.permute(*d))(hw, 0, 1, 3, 2, 4, 5)
    hw = hw.reshape(-1, ws * ws, C)
    qkv = (hw @ w_qkv).reshape(-1, ws * ws, 3, nh, dh)
    q = qkv[:, :, 0].clone()
    k = qkv[:, :, 1].clone()
    v = qkv[:, :, 2].clone()
    scale = dh ** (-0.5)
    attn = torch.einsum('wnhd,wmhd->whnm', q, k) * scale
    attn = _softmax(attn, axis=-1)
    out = torch.einsum('whnm,wmhd->wnhd', attn, v)
    out = out.reshape(-1, ws * ws, C) @ w_o
    out = out.reshape(B, H // ws, W // ws, ws, ws, C)
    out = (lambda x, *d: x.permute(*d))(out, 0, 1, 3, 2, 4, 5)
    out = out.reshape(B, H, W, C)
    return x0 + out
```

```asm
; @launch grid=(256,1,1) block=(256,1,1) lds=163328
.amdgcn_target "amdgcn-amd-amdhsa--gfx950"
.text
.globl standalone__window_attn_davit__vision_kernel
.p2align 12
.p2align 8
.type standalone__window_attn_davit__vision_kernel,@function
standalone__window_attn_davit__vision_kernel:

    s_cmp_ge_u32 s2, 256
    s_cbranch_scc1 L_end
    s_getpc_b64 s[62:63]
    s_load_dwordx8 s[4:11], s[0:1], 0
    s_load_dwordx2 s[12:13], s[0:1], 32
    s_load_dwordx2 s[16:17], s[0:1], 48
    v_lshrrev_b32 v1, 6, v0
    s_and_b32 s57, s2, 7
    s_lshl_b32 s57, s57, 2
    v_readfirstlane_b32 s52, v1
    s_lshr_b32 s3, s2, 6
    s_add_u32 s57, s57, s3
    s_bfe_u32 s58, s2, 0x30003
    s_lshl_b32 s58, s58, 2
    s_mul_i32 s53, s57, 602112
    s_mul_i32 s3, s58, 2688
    s_add_u32 s53, s53, s3
    s_mov_b32 s88, s53
    s_lshl_b32 s55, s52, 10
    s_mov_b32 s22, 19353984
    s_mov_b32 s23, 0x20000
    s_cmp_eq_u32 s57, 0
    s_cselect_b32 s26, 0, s22
    s_mov_b32 s27, 0x20000
    s_cmp_eq_u32 s57, 31
    s_cselect_b32 s30, 0, s22
    s_mov_b32 s31, 0x20000
    s_mov_b32 s34, 221184
    s_mov_b32 s35, 0x20000
    s_mov_b32 s38, 73728
    s_mov_b32 s39, 0x20000
    s_mov_b32 s46, 3456
    s_mov_b32 s47, 0x20000
    s_cmp_eq_u32 s52, 3
    s_cselect_b32 s78, 22, 0
    s_lshl_b32 s79, s78, 4
    s_sub_u32 s79, s55, s79
    s_mul_i32 s61, s52, 96
    s_mul_i32 s56, s52, 9216
    s_add_u32 s56, s56, 58368

    v_mov_b32 v104, 0x80000000
    v_subrev_u32 v246, s78, v0
    v_mul_u32_u24 v243, 2521, v246
    v_lshrrev_b32 v243, 16, v243
    v_mul_u32_u24 v244, 26, v243
    v_sub_u32 v244, v246, v244
    v_mul_u32_u24 v245, 384, v243
    v_lshl_add_u32 v245, v244, 4, v245
    v_cmp_gt_u32 vcc, 24, v244
    v_mul_u32_u24 v243, 21846, v243
    v_lshrrev_b32 v243, 16, v243
    v_cndmask_b32 v16, v104, v245, vcc
    v_mul_u32_u24 v243, 1536, v243
    v_add_u32 v243, 3840, v243
    v_add_u32 v253, v16, v243
    s_cmp_eq_u32 s58, 0
    s_cselect_b32 s64, 384, 0
    v_cmp_le_u32 vcc, s64, v16
    v_mov_b32 v252, 0x80000000
    v_and_b32 v240, 63, v0
    v_cndmask_b32 v252, v252, v16, vcc
    v_bfe_u32 v241, v0, 4, 2
    v_and_b32 v242, 15, v0
    v_and_b32 v243, 1, v241
    v_lshrrev_b32 v244, 1, v241
    v_lshlrev_b32 v220, 5, v0
    s_lshr_b32 s65, s2, 3
    s_mul_i32 s66, s65, 2304
    s_and_b32 s67, s65, 31
    s_mul_i32 s67, s67, 1152
    s_mul_i32 s65, s65, 6912
    v_min_u32 v222, 6908, v220
    v_min_u32 v220, 2300, v220
    v_lshlrev_b32 v224, 3, v0
    v_min_u32 v224, 1148, v224
    v_add_u32 v224, s67, v224
    global_load_dword v225, v224, s[62:63]
    v_lshl_add_u32 v246, v242, 1, s61
    v_mul_u32_u24 v245, 1152, v243
    v_add_u32 v245, v245, v246
    v_mul_u32_u24 v247, 384, v244
    v_add_u32 v164, v245, v247
    v_lshl_add_u32 v165, v247, 1, v245
    v_lshl_add_u32 v166, v247, 1, v246
    v_add_u32 v245, 0, v240
    v_mul_u32_u24 v246, 10923, v245
    v_lshrrev_b32 v246, 16, v246
    v_mul_u32_u24 v246, 1056, v246
    v_lshl_add_u32 v245, v245, 4, s61
    v_add_u32 v12, v245, v246
    v_add_u32 v245, 64, v240
    v_mul_u32_u24 v246, 10923, v245
    v_lshrrev_b32 v246, 16, v246
    v_mul_u32_u24 v246, 1056, v246
    v_lshl_add_u32 v245, v245, 4, s61
    v_add_u32 v13, v245, v246
    v_subrev_u32 v13, 1024, v13
    v_add_u32 v245, 128, v240
    v_mul_u32_u24 v246, 10923, v245
    v_lshrrev_b32 v246, 16, v246
    v_mul_u32_u24 v246, 1056, v246
    v_lshl_add_u32 v245, v245, 4, s61
    v_add_u32 v14, v245, v246
    v_subrev_u32 v14, 2048, v14
    s_waitcnt lgkmcnt(0)
    s_mov_b32 s32, s8
    s_mov_b32 s33, s9
    s_mov_b32 s36, s10
    s_mov_b32 s37, s11
    s_mov_b32 s44, s6
    s_mov_b32 s45, s7
    s_sub_u32 s20, s4, 86400
    s_subb_u32 s21, s5, 0
    s_mov_b32 s24, s20
    s_mov_b32 s25, s21
    s_mov_b32 s28, s20
    s_mov_b32 s29, s21
    buffer_load_dword v221, v222, s[32:35], s65 offen
    buffer_load_dword v223, v220, s[36:39], s66 offen
    s_add_u32 m0, s79, 0
    s_add_u32 s18, s88, 0
    buffer_load_dwordx4 v252, s[24:27], s18 offen nt lds
    s_mov_b32 s40, s12
    s_mov_b32 s41, s13
    s_mov_b32 s42, 19267584
    s_mov_b32 s43, 0x20000
    s_mov_b32 s48, s16
    s_mov_b32 s49, s17
    s_mov_b32 s50, 0x10000000
    s_mov_b32 s51, 0x20000
    s_add_u32 s89, s53, 2688
    s_add_u32 s90, s53, 5376
    s_add_u32 s91, s53, 8064
    s_mov_b32 s54, 0x3e553b95
    s_mov_b32 s59, 0x3baaaaab
    s_mov_b32 s60, 0x3727c5ac
    s_add_u32 m0, s79, 3744
    s_add_u32 s18, s88, 86016
    buffer_load_dwordx4 v252, s[20:23], s18 offen nt lds
    v_lshrrev_b32 v245, 2, v240
    v_mul_u32_u24 v245, 96, v245
    v_and_b32 v246, 3, v240
    v_lshl_add_u32 v245, v246, 3, v245
    v_add_u32 v18, s56, v245
    v_lshlrev_b32 v245, 4, v240
    v_add_u32 v7, 95232, v245
    v_add_u32 v8, s55, v7
    s_lshr_b32 s68, s52, 1
    s_lshl_b32 s68, s68, 10
    s_and_b32 s69, s52, 1
    s_lshl_b32 s69, s69, 3
    s_add_u32 s68, s68, s69
    s_add_u32 s68, s68, 4096
    buffer_load_ushort v168, v164, s[44:47], 0 offen offset:0
    buffer_load_ushort v169, v164, s[44:47], 0 offen offset:32
    buffer_load_ushort v170, v164, s[44:47], 0 offen offset:64
    buffer_load_ushort v171, v165, s[44:47], 0 offen offset:768
    buffer_load_ushort v172, v165, s[44:47], 0 offen offset:800
    buffer_load_ushort v173, v165, s[44:47], 0 offen offset:832
    buffer_load_ushort v174, v166, s[44:47], 0 offen offset:2304
    buffer_load_ushort v175, v166, s[44:47], 0 offen offset:2336
    buffer_load_ushort v176, v166, s[44:47], 0 offen offset:2368
    s_add_u32 m0, s79, 7488
    s_add_u32 s18, s88, 172032
    buffer_load_dwordx4 v252, s[20:23], s18 offen nt lds
    v_add_u32 v9, s68, v7
    s_mul_i32 s70, s52, 6144
    s_add_u32 s70, s70, 33792
    v_add_u32 v17, s70, v245
    v_lshlrev_b32 v11, 2, v242
    v_lshlrev_b32 v245, 5, v242
    v_add_u32 v245, 158208, v245
    v_lshl_add_u32 v245, v244, 9, v245
    v_lshl_add_u32 v245, v243, 4, v245
    s_lshl_b32 s71, s52, 2
    v_add_u32 v10, s71, v245
    v_and_b32 v245, 3, v242
    v_mul_u32_u24 v19, 21845, v245
    v_add_u32 v246, 0, v242
    s_add_u32 m0, s79, 11232
    s_add_u32 s18, s88, 258048
    buffer_load_dwordx4 v252, s[20:23], s18 offen nt lds
    v_mul_u32_u24 v245, 9363, v246
    v_lshrrev_b32 v245, 16, v245
    v_mul_u32_u24 v245, 6656, v245
    v_mul_u32_u24 v246, 416, v246
    v_sub_u32 v245, v246, v245
    v_add_u32 v245, 22464, v245
    v_add_u32 v245, s61, v245
    v_lshl_add_u32 v245, v243, 4, v245
    v_mul_u32_u24 v246, 3744, v244
    v_add_u32 v1, v245, v246
    v_mul_u32_u24 v246, 832, v244
    v_add_u32 v4, v245, v246
    v_add_u32 v246, 16, v242
    v_cmp_ne_u32 vcc, 24, v246
    s_add_u32 m0, s79, 14976
    s_add_u32 s18, s88, 344064
    buffer_load_dwordx4 v252, s[20:23], s18 offen nt lds
    v_mov_b32 v247, 12480
    v_cndmask_b32 v246, 48, v246, vcc
    v_mul_u32_u24 v245, 9363, v246
    v_lshrrev_b32 v245, 16, v245
    v_mul_u32_u24 v245, 6656, v245
    v_mul_u32_u24 v246, 416, v246
    v_sub_u32 v245, v246, v245
    v_add_u32 v245, 22464, v245
    v_add_u32 v245, s61, v245
    v_lshl_add_u32 v245, v243, 4, v245
    v_mul_u32_u24 v246, 3744, v244
    v_add_u32 v2, v245, v246
    v_mul_u32_u24 v246, 832, v244
    v_add_u32 v5, v245, v246
    s_add_u32 m0, s56, 0
    s_mov_b32 s18, 384
    buffer_load_dwordx4 v12, s[32:35], s18 offen offset:0 lds
    v_add_u32 v246, 32, v242
    v_mul_u32_u24 v245, 9363, v246
    v_lshrrev_b32 v245, 16, v245
    v_mul_u32_u24 v245, 6656, v245
    v_mul_u32_u24 v246, 416, v246
    v_sub_u32 v245, v246, v245
    v_add_u32 v245, 22464, v245
    v_add_u32 v245, s61, v245
    v_lshl_add_u32 v245, v243, 4, v245
    v_mul_u32_u24 v246, 3744, v244
    v_add_u32 v3, v245, v246
    v_mul_u32_u24 v246, 832, v244
    v_add_u32 v6, v245, v246
    v_lshrrev_b32 v245, 2, v242
    buffer_load_dwordx4 v13, s[32:35], s18 offen offset:1024 lds
    v_mul_u32_u24 v246, 1248, v245
    v_add_u32 v246, 32544, v246
    v_cmp_ne_u32 vcc, 0, v245
    s_mul_i32 s72, s52, 768
    s_add_u32 s72, s72, 160256
    v_cndmask_b32 v246, v247, v246, vcc
    v_lshl_add_u32 v246, v243, 4, v246
    v_add_u32 v246, s61, v246
    v_mul_u32_u24 v247, 3744, v244
    v_add_u32 v152, v246, v247
    v_mul_u32_u24 v247, 832, v244
    v_add_u32 v153, v246, v247
    v_lshlrev_b32 v246, 4, v240
    v_lshrrev_b32 v15, 6, v246
    v_lshl_add_u32 v15, v15, 4, s72
    v_mov_b32 v246, 0x3f803f80
    buffer_load_dwordx4 v14, s[32:35], s18 offen offset:2048 lds
    v_cmp_eq_u32 vcc, 0, v19
    v_cmp_eq_u32 s[80:81], 0, v245
    v_cmp_eq_u32 s[82:83], 1, v245
    v_cndmask_b32_e64 v246, 0, v246, vcc
    v_accvgpr_write_b32 a252, v246
    v_accvgpr_write_b32 a253, v246
    v_accvgpr_write_b32 a254, v246
    v_accvgpr_write_b32 a255, v246
    v_cmp_eq_u32 s[84:85], 2, v245
    v_cmp_eq_u32 s[86:87], 3, v245
    v_cmp_ne_u32 vcc, 2, v241
    v_mov_b32 v246, 0x3f80
    v_and_b32 v245, 1, v242
    v_lshlrev_b32 v245, 4, v245
    v_lshlrev_b32 v247, 2, v243
    s_mov_b32 s19, -32256
    s_add_u32 m0, s79, 18720
    s_add_u32 s18, s88, 430080
    buffer_load_dwordx4 v252, s[20:23], s18 offen nt lds
    v_mov_b32 v0, 0xff800000
    s_mul_i32 s73, s52, 800
    s_add_u32 s73, s73, 95232
    s_cmp_eq_u32 s52, 3
    s_cselect_b32 s74, 6, 64
    s_mul_i32 s75, s52, 768
    s_cmp_eq_u32 s52, 1
    s_cselect_b32 s76, 3, 64
    s_cmp_eq_u32 s52, 3
    s_cselect_b32 s77, 0x80000000, 0
    s_cmp_eq_u32 s58, 28
    s_cselect_b32 s64, 3072, -1
    s_mul_i32 s65, s52, 768
    s_add_u32 s65, s65, 160256
    s_add_u32 m0, s79, 22464
    s_add_u32 s18, s88, 516096
    buffer_load_dwordx4 v252, s[20:23], s18 offen nt lds
    s_mul_i32 s66, s52, 400
    s_mul_i32 s67, s52, 2688
    s_add_u32 s67, s67, 259200
    s_add_u32 m0, s56, 3072
    s_mov_b32 s18, 37248
    buffer_load_dwordx4 v12, s[32:35], s18 offen offset:0 lds
    buffer_load_dwordx4 v13, s[32:35], s18 offen offset:1024 lds
    s_waitcnt vmcnt(15)
    v_cndmask_b32 v171, v246, v171, vcc
    s_waitcnt vmcnt(14)
    v_cndmask_b32 v172, v246, v172, vcc
    s_waitcnt vmcnt(13)
    v_cndmask_b32 v173, v246, v173, vcc
    v_cndmask_b32 v68, 0, v168, s[80:81]
    v_cndmask_b32 v69, 0, v168, s[82:83]
    v_cndmask_b32 v70, 0, v168, s[84:85]
    v_cndmask_b32 v71, 0, v168, s[86:87]
    v_cndmask_b32 v72, 0, v171, s[80:81]
    v_cndmask_b32 v73, 0, v171, s[82:83]
    v_cndmask_b32 v74, 0, v171, s[84:85]
    v_cndmask_b32 v75, 0, v171, s[86:87]
    v_cndmask_b32 v76, 0, v169, s[80:81]
    v_cndmask_b32 v77, 0, v169, s[82:83]
    v_cndmask_b32 v78, 0, v169, s[84:85]
    v_cndmask_b32 v79, 0, v169, s[86:87]
    v_cndmask_b32 v80, 0, v172, s[80:81]
    v_cndmask_b32 v81, 0, v172, s[82:83]
    v_cndmask_b32 v82, 0, v172, s[84:85]
    v_cndmask_b32 v83, 0, v172, s[86:87]
    v_cndmask_b32 v84, 0, v170, s[80:81]
    v_cndmask_b32 v85, 0, v170, s[82:83]
    v_cndmask_b32 v86, 0, v170, s[84:85]
    v_cndmask_b32 v87, 0, v170, s[86:87]
    v_cndmask_b32 v88, 0, v173, s[80:81]
    v_cndmask_b32 v89, 0, v173, s[82:83]
    v_cndmask_b32 v90, 0, v173, s[84:85]
    v_cndmask_b32 v91, 0, v173, s[86:87]
    v_lshrrev_b32 v246, 1, v242
    v_sub_u32 v246, v246, v247
    v_cmp_eq_u32 s[80:81], 0, v246
    v_cmp_eq_u32 s[82:83], 1, v246
    v_cmp_eq_u32 s[84:85], 2, v246
    v_cmp_eq_u32 s[86:87], 3, v246
    s_waitcnt vmcnt(12)
    v_lshlrev_b32 v174, v245, v174
    v_cndmask_b32 v20, 0, v174, s[80:81]
    v_cndmask_b32 v21, 0, v174, s[82:83]
    v_cndmask_b32 v22, 0, v174, s[84:85]
    v_cndmask_b32 v23, 0, v174, s[86:87]
    s_waitcnt vmcnt(11)
    v_lshlrev_b32 v175, v245, v175
    v_cndmask_b32 v24, 0, v175, s[80:81]
    v_cndmask_b32 v25, 0, v175, s[82:83]
    v_cndmask_b32 v26, 0, v175, s[84:85]
    v_cndmask_b32 v27, 0, v175, s[86:87]
    s_waitcnt vmcnt(10)
    v_lshlrev_b32 v176, v245, v176
    v_cndmask_b32 v28, 0, v176, s[80:81]
    v_cndmask_b32 v29, 0, v176, s[82:83]
    v_cndmask_b32 v30, 0, v176, s[84:85]
    v_cndmask_b32 v31, 0, v176, s[86:87]
    v_lshlrev_b32 v172, 3, v11
    v_add_u32 v172, 158208, v172
    v_cmp_eq_u32 vcc, 0, v19
    s_mov_b32 s80, 0x10001
    s_mov_b32 s81, 0x10001
    buffer_load_dwordx4 v14, s[32:35], s18 offen offset:2048 lds
    s_add_u32 m0, s79, 26208
    s_add_u32 s18, s88, 602112
    buffer_load_dwordx4 v252, s[20:23], s18 offen nt lds
    s_waitcnt vmcnt(9)
    s_barrier
    s_add_u32 m0, s79, 29952
    s_add_u32 s18, s88, 688128
    buffer_load_dwordx4 v252, s[28:31], s18 offen nt lds
    ds_read_b128 v[232:235], v6 offset:7488
    ds_read_b128 v[180:183], v3 offset:0
    ds_read_b128 v[184:187], v3 offset:416
    ds_read_b128 v[188:191], v3 offset:832
    ds_read_b128 v[192:195], v3 offset:4160
    ds_read_b128 v[236:239], v6 offset:7520
    s_add_u32 m0, s56, 6144
    s_mov_b32 s18, 74112
    buffer_load_dwordx4 v12, s[32:35], s18 offen offset:0 lds
    ds_read_b128 v[128:131], v3 offset:32
    s_waitcnt lgkmcnt(6)
    v_mfma_f32_16x16x32_bf16 v[56:59], v[20:23], v[232:235], 0
    s_waitcnt lgkmcnt(4)
    ds_read_b128 v[132:135], v3 offset:448
    ds_read_b128 v[136:139], v3 offset:864
    ds_read_b128 v[140:143], v3 offset:4192
    s_nop 1
    v_smfmac_f32_16x16x64_bf16 v[56:59], v[68:71], v[180:187], v19
    s_waitcnt lgkmcnt(5)
    buffer_load_dwordx4 v13, s[32:35], s18 offen offset:1024 lds
    v_smfmac_f32_16x16x64_bf16 v[56:59], v[72:75], v[188:195], v19
    s_waitcnt lgkmcnt(4)
    ds_read_b128 v[176:179], v6 offset:7552
    ds_read_b128 v[144:147], v3 offset:64
    v_mfma_f32_16x16x32_bf16 v[60:63], v[24:27], v[236:239], 0
    s_waitcnt vmcnt(9)
    ds_read_b128 v[148:151], v3 offset:480
    ds_read_b64_tr_b16 a[0:1], v18 offset:0
    ds_read_b64_tr_b16 a[24:25], v18 offset:32
    v_add_f32 v158, v56, v57
    v_mul_f32 v159, v56, v56
    s_waitcnt lgkmcnt(7)
    v_smfmac_f32_16x16x64_bf16 v[60:63], v[76:79], v[128:135], v19
    s_waitcnt lgkmcnt(5)
    ds_read_b64_tr_b16 a[48:49], v18 offset:64
    buffer_load_dwordx4 v14, s[32:35], s18 offen offset:2048 lds
    v_smfmac_f32_16x16x64_bf16 v[60:63], v[80:83], v[136:143], v19
    s_waitcnt lgkmcnt(5)
    ds_read_b64_tr_b16 a[2:3], v18 offset:1536
    ds_read_b64_tr_b16 a[26:27], v18 offset:1568
    v_mfma_f32_16x16x32_bf16 v[64:67], v[28:31], v[176:179], 0
    s_waitcnt lgkmcnt(5)
    ds_read_b64_tr_b16 a[50:51], v18 offset:1600
    ds_read_b128 v[180:183], v3 offset:896
    ds_read_b128 v[184:187], v3 offset:4224
    v_fmac_f32 v159, v57, v57
    v_add_f32 v158, v158, v58
    v_fmac_f32 v159, v58, v58
    v_smfmac_f32_16x16x64_bf16 v[64:67], v[84:87], v[144:151], v19
    v_add_f32 v158, v158, v59
    v_fmac_f32 v159, v59, v59
    s_add_u32 m0, s56, 36864
    s_mov_b32 s18, 110976
    buffer_load_dwordx4 v12, s[32:35], s18 offen offset:0 lds
    v_add_f32 v158, v158, v60
    v_fmac_f32 v159, v60, v60
    v_add_f32 v158, v158, v61
    v_fmac_f32 v159, v61, v61
    v_add_f32 v158, v158, v62
    v_fmac_f32 v159, v62, v62
    v_add_f32 v158, v158, v63
    v_fmac_f32 v159, v63, v63
    s_waitcnt lgkmcnt(0)
    v_smfmac_f32_16x16x64_bf16 v[64:67], v[88:91], v[180:187], v19
    s_nop 7
    v_add_f32 v158, v158, v64
    v_fmac_f32 v159, v64, v64
    v_add_f32 v158, v158, v65
    v_fmac_f32 v159, v65, v65
    v_add_f32 v158, v158, v66
    v_fmac_f32 v159, v66, v66
    v_add_f32 v158, v158, v67
    v_fmac_f32 v159, v67, v67
    s_nop 1
    v_permlane16_swap_b32 v158, v159
    v_add_f32 v158, v158, v159
    v_mov_b32 v160, v158
    s_nop 1
    v_permlane32_swap_b32 v158, v160
    v_add_f32 v158, v158, v160
    ds_write_b32 v10, v158 offset:1024
    s_waitcnt vmcnt(9) lgkmcnt(0)
    s_barrier
    buffer_load_dwordx4 v13, s[32:35], s18 offen offset:1024 lds
    ds_read_b128 v[232:235], v5 offset:7488
    ds_read_b128 v[188:191], v2 offset:0
    ds_read_b128 v[192:195], v2 offset:416
    ds_read_b128 v[128:131], v2 offset:832
    ds_read_b128 v[132:135], v2 offset:4160
    ds_read_b128 v[236:239], v5 offset:7520
    buffer_load_dwordx4 v14, s[32:35], s18 offen offset:2048 lds
    ds_read_b128 v[136:139], v2 offset:32
    s_waitcnt lgkmcnt(6)
    v_mfma_f32_16x16x32_bf16 v[44:47], v[20:23], v[232:235], 0
    s_waitcnt lgkmcnt(4)
    ds_read_b128 v[140:143], v2 offset:448
    ds_read_b128 v[144:147], v2 offset:864
    ds_read_b128 v[148:151], v2 offset:4192
    s_nop 1
    v_smfmac_f32_16x16x64_bf16 v[44:47], v[68:71], v[188:195], v19
    s_waitcnt lgkmcnt(5)
    ds_read_b128 v[176:179], v5 offset:7552
    v_smfmac_f32_16x16x64_bf16 v[44:47], v[72:75], v[128:135], v19
    s_waitcnt lgkmcnt(5)
    s_add_u32 m0, s56, 39936
    s_mov_b32 s18, 147840
    buffer_load_dwordx4 v12, s[32:35], s18 offen offset:0 lds
    v_mfma_f32_16x16x32_bf16 v[48:51], v[24:27], v[236:239], 0
    s_waitcnt vmcnt(9)
    ds_read_b128 v[180:183], v2 offset:64
    ds_read_b128 v[184:187], v2 offset:480
    ds_read_b64_tr_b16 a[16:17], v18 offset:3072
    ds_read_b64_tr_b16 a[40:41], v18 offset:3104
    ds_read_b64_tr_b16 a[64:65], v18 offset:3136
    s_waitcnt lgkmcnt(8)
    v_smfmac_f32_16x16x64_bf16 v[48:51], v[76:79], v[136:143], v19
    s_waitcnt lgkmcnt(6)
    ds_read_b64_tr_b16 a[4:5], v18 offset:4608
    ds_read_b64_tr_b16 a[28:29], v18 offset:4640
    v_smfmac_f32_16x16x64_bf16 v[48:51], v[80:83], v[144:151], v19
    s_waitcnt lgkmcnt(7)
    buffer_load_dwordx4 v13, s[32:35], s18 offen offset:1024 lds
    v_mfma_f32_16x16x32_bf16 v[52:55], v[28:31], v[176:179], 0
    s_waitcnt lgkmcnt(5)
    ds_read_b64_tr_b16 a[52:53], v18 offset:4672
    ds_read_b128 v[188:191], v2 offset:896
    ds_read_b128 v[192:195], v2 offset:4224
    v_add_f32 v158, v44, v45
    v_mul_f32 v159, v44, v44
    v_fmac_f32 v159, v45, v45
    v_add_f32 v158, v158, v46
    v_smfmac_f32_16x16x64_bf16 v[52:55], v[84:87], v[180:187], v19
    ds_read_b128 v[164:167], v172 offset:1024
    ds_read_b128 v[168:171], v172 offset:1040
    v_fmac_f32 v159, v46, v46
    v_add_f32 v158, v158, v47
    v_fmac_f32 v159, v47, v47
    v_add_f32 v158, v158, v48
    v_fmac_f32 v159, v48, v48
    v_add_f32 v158, v158, v49
    v_fmac_f32 v159, v49, v49
    v_add_f32 v158, v158, v50
    v_fmac_f32 v159, v50, v50
    v_add_f32 v158, v158, v51
    v_fmac_f32 v159, v51, v51
    v_lshlrev_b32 v172, 3, v11
    v_add_u32 v172, 158208, v172
    s_waitcnt lgkmcnt(2)
    v_smfmac_f32_16x16x64_bf16 v[52:55], v[88:91], v[188:195], v19
    s_waitcnt lgkmcnt(1)
    v_add_f32 v164, v164, v165
    v_add_f32 v166, v166, v167
    v_add_f32 v164, v164, v166
    v_mul_f32 v164, s59, v164
    s_waitcnt lgkmcnt(0)
    v_add_f32 v168, v168, v169
    v_add_f32 v170, v170, v171
    v_add_f32 v168, v168, v170
    v_fma_f32 v165, v164, v164, -s60
    v_fma_f32 v168, v168, s59, -v165
    v_max_f32 v168, s60, v168
    v_rsq_f32 v250, v168
    v_add_f32 v158, v158, v52
    buffer_load_dwordx4 v14, s[32:35], s18 offen offset:2048 lds
    v_mul_f32 v251, v164, v250
    v_fma_f32 v246, v56, v250, -v251
    v_fma_f32 v247, v57, v250, -v251
    v_cvt_pk_bf16_f32 v240, v246, v247
    v_fma_f32 v246, v58, v250, -v251
    v_fma_f32 v247, v59, v250, -v251
    v_cvt_pk_bf16_f32 v241, v246, v247
    v_fma_f32 v246, v60, v250, -v251
    v_fma_f32 v247, v61, v250, -v251
    v_cvt_pk_bf16_f32 v242, v246, v247
    v_fma_f32 v246, v62, v250, -v251
    v_fma_f32 v247, v63, v250, -v251
    v_cvt_pk_bf16_f32 v243, v246, v247
    v_fma_f32 v246, v64, v250, -v251
    v_fma_f32 v247, v65, v250, -v251
    v_cvt_pk_bf16_f32 v244, v246, v247
    v_fma_f32 v246, v66, v250, -v251
    v_fma_f32 v247, v67, v250, -v251
    v_cvt_pk_bf16_f32 v245, v246, v247
    ds_write_b128 v8, v[240:243] offset:49920
    v_fmac_f32 v159, v52, v52
    v_add_f32 v158, v158, v53
    v_fmac_f32 v159, v53, v53
    v_add_f32 v158, v158, v54
    v_fmac_f32 v159, v54, v54
    v_add_f32 v158, v158, v55
    v_fmac_f32 v159, v55, v55
    s_nop 1
    v_permlane16_swap_b32 v158, v159
    v_add_f32 v158, v158, v159
    v_mov_b32 v160, v158
    ds_write_b64 v9, v[244:245] offset:49920
    s_nop 0
    v_permlane32_swap_b32 v158, v160
    v_add_f32 v158, v158, v160
    ds_write_b32 v10, v158 offset:0
    s_add_u32 m0, s56, 43008
    s_mov_b32 s18, 184704
    buffer_load_dwordx4 v12, s[32:35], s18 offen offset:0 lds
    s_waitcnt vmcnt(10) lgkmcnt(0)
    s_barrier
    ds_read_b128 v[232:235], v4 offset:7488
    ds_read_b128 v[128:131], v1 offset:0
    ds_read_b128 v[132:135], v1 offset:416
    ds_read_b128 v[136:139], v1 offset:832
    buffer_load_dwordx4 v13, s[32:35], s18 offen offset:1024 lds
    ds_read_b128 v[140:143], v1 offset:4160
    ds_read_b128 v[236:239], v4 offset:7520
    ds_read_b128 v[144:147], v1 offset:32
    s_waitcnt lgkmcnt(6)
    v_mfma_f32_16x16x32_bf16 v[32:35], v[20:23], v[232:235], 0
    s_waitcnt lgkmcnt(4)
    ds_read_b128 v[148:151], v1 offset:448
    ds_read_b128 v[180:183], v1 offset:864
    buffer_load_dwordx4 v14, s[32:35], s18 offen offset:2048 lds
    ds_read_b128 v[184:187], v1 offset:4192
    s_nop 0
    v_smfmac_f32_16x16x64_bf16 v[32:35], v[68:71], v[128:135], v19
    s_waitcnt lgkmcnt(5)
    ds_read_b128 v[176:179], v4 offset:7552
    v_smfmac_f32_16x16x64_bf16 v[32:35], v[72:75], v[136:143], v19
    s_waitcnt lgkmcnt(5)
    ds_read_b128 v[188:191], v1 offset:64
    v_mfma_f32_16x16x32_bf16 v[36:39], v[24:27], v[236:239], 0
    s_waitcnt vmcnt(9)
    ds_read_b128 v[192:195], v1 offset:480
    ds_read_b64_tr_b16 a[6:7], v18 offset:6144
    s_add_u32 m0, s79, 33792
    s_add_u32 s18, s88, 258048
    buffer_load_dwordx4 v253, s[20:23], s18 offen nt lds
    ds_read_b64_tr_b16 a[30:31], v18 offset:6176
    ds_read_b64_tr_b16 a[54:55], v18 offset:6208
    s_waitcnt lgkmcnt(8)
    v_smfmac_f32_16x16x64_bf16 v[36:39], v[76:79], v[144:151], v19
    s_waitcnt lgkmcnt(6)
    ds_read_b64_tr_b16 a[18:19], v18 offset:7680
    ds_read_b64_tr_b16 a[42:43], v18 offset:7712
    v_smfmac_f32_16x16x64_bf16 v[36:39], v[80:83], v[180:187], v19
    s_waitcnt lgkmcnt(7)
    ds_read_b64_tr_b16 a[66:67], v18 offset:7744
    ds_read_b128 v[128:131], v1 offset:896
    v_mfma_f32_16x16x32_bf16 v[40:43], v[28:31], v[176:179], 0
    s_waitcnt lgkmcnt(7)
    ds_read_b128 v[132:135], v1 offset:4224
    ds_read_b128 v[164:167], v172 offset:0
    s_add_u32 m0, s79, 37536
    s_add_u32 s18, s88, 344064
    buffer_load_dwordx4 v253, s[20:23], s18 offen nt lds
    ds_read_b128 v[168:171], v172 offset:16
    v_add_f32 v158, v32, v33
    v_mul_f32 v159, v32, v32
    v_smfmac_f32_16x16x64_bf16 v[40:43], v[84:87], v[188:195], v19
    s_waitcnt lgkmcnt(2)
    ds_read_b128 v[220:223], v7 offset:49920
    ds_read_b128 v[224:227], v7 offset:50944
    v_fmac_f32 v159, v33, v33
    v_add_f32 v158, v158, v34
    v_fmac_f32 v159, v34, v34
    v_add_f32 v158, v158, v35
    v_fmac_f32 v159, v35, v35
    v_add_f32 v158, v158, v36
    v_fmac_f32 v159, v36, v36
    s_add_u32 m0, s79, 41280
    s_add_u32 s18, s88, 430080
    buffer_load_dwordx4 v253, s[20:23], s18 offen nt lds
    v_smfmac_f32_16x16x64_bf16 v[40:43], v[88:91], v[128:135], v19
    s_waitcnt lgkmcnt(3)
    ds_read_b128 v[228:231], v7 offset:51968
    v_add_f32 v164, v164, v165
    v_add_f32 v166, v166, v167
    s_waitcnt lgkmcnt(3)
    v_add_f32 v168, v168, v169
    v_add_f32 v170, v170, v171
    s_waitcnt vmcnt(9)
    ds_read_b64_tr_b16 a[8:9], v18 offset:36864
    s_waitcnt lgkmcnt(3)
    v_mfma_f32_16x16x32_bf16 v[196:199], a[0:3], v[220:223], 0
    s_waitcnt lgkmcnt(2)
    ds_read_b64_tr_b16 a[32:33], v18 offset:36896
    ds_read_b64_tr_b16 a[56:57], v18 offset:36928
    v_mfma_f32_16x16x32_bf16 v[196:199], a[4:7], v[224:227], v[196:199]
    s_add_u32 m0, s56, 0
    s_mov_b32 s18, 0
    buffer_load_dwordx4 v12, s[32:35], s18 offen offset:0 lds
    v_mfma_f32_16x16x32_bf16 v[200:203], a[24:27], v[220:223], 0
    ds_read_b64_tr_b16 a[10:11], v18 offset:38400
    ds_read_b64_tr_b16 a[34:35], v18 offset:38432
    v_mfma_f32_16x16x32_bf16 v[200:203], a[28:31], v[224:227], v[200:203]
    ds_read_b64_tr_b16 a[58:59], v18 offset:38464
    v_add_f32 v164, v164, v166
    v_mfma_f32_16x16x32_bf16 v[204:207], a[48:51], v[220:223], 0
    ds_read_b128 v[220:223], v7 offset:52992
    v_add_f32 v168, v168, v170
    v_mfma_f32_16x16x32_bf16 v[204:207], a[52:55], v[224:227], v[204:207]
    s_waitcnt lgkmcnt(3)
    ds_read_b128 v[224:227], v7 offset:54016
    buffer_load_dwordx4 v13, s[32:35], s18 offen offset:1024 lds
    v_mul_f32 v164, s59, v164
    v_fma_f32 v165, v164, v164, -s60
    v_fma_f32 v168, v168, s59, -v165
    v_max_f32 v168, s60, v168
    v_mfma_f32_16x16x32_bf16 v[196:199], a[8:11], v[228:231], v[196:199]
    s_waitcnt lgkmcnt(3)
    v_rsq_f32 v248, v168
    v_mfma_f32_16x16x32_bf16 v[200:203], a[32:35], v[228:231], v[200:203]
    s_waitcnt lgkmcnt(2)
    v_mul_f32 v249, v164, v248
    v_fma_f32 v246, v44, v248, -v249
    v_mfma_f32_16x16x32_bf16 v[204:207], a[56:59], v[228:231], v[204:207]
    s_waitcnt vmcnt(8)
    ds_read_b128 v[228:231], v7 offset:55040
    v_fma_f32 v247, v45, v248, -v249
    buffer_load_dwordx4 v14, s[32:35], s18 offen offset:2048 lds
    v_cvt_pk_bf16_f32 v240, v246, v247
    v_fma_f32 v246, v46, v248, -v249
    v_fma_f32 v247, v47, v248, -v249
    v_cvt_pk_bf16_f32 v241, v246, v247
    v_fma_f32 v246, v48, v248, -v249
    ds_read_b64_tr_b16 a[20:21], v18 offset:39936
    ds_read_b64_tr_b16 a[44:45], v18 offset:39968
    ds_read_b64_tr_b16 a[68:69], v18 offset:40000
    ds_read_b64_tr_b16 a[12:13], v18 offset:41472
    ds_read_b64_tr_b16 a[36:37], v18 offset:41504
    ds_read_b64_tr_b16 a[60:61], v18 offset:41536
    v_fma_f32 v247, v49, v248, -v249
    v_cvt_pk_bf16_f32 v242, v246, v247
    v_fma_f32 v246, v50, v248, -v249
    s_add_u32 m0, s56, 3072
    s_mov_b32 s18, 36864
    buffer_load_dwordx4 v12, s[32:35], s18 offen offset:0 lds
    v_fma_f32 v247, v51, v248, -v249
    v_cvt_pk_bf16_f32 v243, v246, v247
    v_fma_f32 v246, v52, v248, -v249
    v_fma_f32 v247, v53, v248, -v249
    v_cvt_pk_bf16_f32 v244, v246, v247
    v_fma_f32 v246, v54, v248, -v249
    v_fma_f32 v247, v55, v248, -v249
    v_cvt_pk_bf16_f32 v245, v246, v247
    ds_write_b128 v8, v[240:243] offset:43776
    v_add_f32 v158, v158, v37
    v_fmac_f32 v159, v37, v37
    v_add_f32 v158, v158, v38
    v_fmac_f32 v159, v38, v38
    v_add_f32 v158, v158, v39
    v_fmac_f32 v159, v39, v39
    v_add_f32 v158, v158, v40
    v_fmac_f32 v159, v40, v40
    v_add_f32 v158, v158, v41
    v_fmac_f32 v159, v41, v41
    v_add_f32 v158, v158, v42
    v_fmac_f32 v159, v42, v42
    v_add_f32 v158, v158, v43
    v_fmac_f32 v159, v43, v43
    v_lshlrev_b32 v172, 3, v11
    ds_write_b64 v9, v[244:245] offset:43776
    buffer_load_dwordx4 v13, s[32:35], s18 offen offset:1024 lds
    v_permlane16_swap_b32 v158, v159
    v_add_f32 v158, v158, v159
    v_mov_b32 v160, v158
    v_add_u32 v172, 158208, v172
    s_nop 0
    v_permlane32_swap_b32 v158, v160
    v_add_f32 v158, v158, v160
    ds_write_b32 v10, v158 offset:1024
    buffer_load_dwordx4 v14, s[32:35], s18 offen offset:2048 lds
    s_waitcnt vmcnt(9)
    ds_read_b64_tr_b16 a[14:15], v18 offset:43008
    ds_read_b64_tr_b16 a[38:39], v18 offset:43040
    s_add_u32 m0, s56, 6144
    s_mov_b32 s18, 73728
    buffer_load_dwordx4 v12, s[32:35], s18 offen offset:0 lds
    ds_read_b64_tr_b16 a[62:63], v18 offset:43072
    ds_read_b64_tr_b16 a[22:23], v18 offset:44544
    ds_read_b64_tr_b16 a[46:47], v18 offset:44576
    ds_read_b64_tr_b16 a[70:71], v18 offset:44608
    s_waitcnt lgkmcnt(5)
    v_mfma_f32_16x16x32_bf16 v[196:199], a[12:15], v[220:223], v[196:199]
    s_waitcnt lgkmcnt(4)
    v_mfma_f32_16x16x32_bf16 v[200:203], a[36:39], v[220:223], v[200:203]
    s_waitcnt lgkmcnt(3)
    v_mfma_f32_16x16x32_bf16 v[204:207], a[60:63], v[220:223], v[204:207]
    v_mfma_f32_16x16x32_bf16 v[204:207], a[64:67], v[224:227], v[204:207]
    s_waitcnt lgkmcnt(0)
    v_mfma_f32_16x16x32_bf16 v[204:207], a[68:71], v[228:231], v[204:207]
    v_mfma_f32_16x16x32_bf16 v[200:203], a[40:43], v[224:227], v[200:203]
    v_mfma_f32_16x16x32_bf16 v[200:203], a[44:47], v[228:231], v[200:203]
    v_mfma_f32_16x16x32_bf16 v[196:199], a[16:19], v[224:227], v[196:199]
    v_mfma_f32_16x16x32_bf16 v[196:199], a[20:23], v[228:231], v[196:199]
    s_nop 3
    v_cvt_pk_bf16_f32 v120, v204, v205
    v_cvt_pk_bf16_f32 v121, v206, v207
    v_cvt_pk_bf16_f32 v118, v200, v201
    v_cvt_pk_bf16_f32 v119, v202, v203
    v_cvt_pk_bf16_f32 v116, v196, v197
    v_cvt_pk_bf16_f32 v117, v198, v199
    buffer_load_dwordx4 v13, s[32:35], s18 offen offset:1024 lds
    buffer_load_dwordx4 v14, s[32:35], s18 offen offset:2048 lds
    s_waitcnt vmcnt(9)
    s_barrier
    s_add_u32 m0, s56, 36864
    s_mov_b32 s18, 110592
    buffer_load_dwordx4 v12, s[32:35], s18 offen offset:0 lds
    ds_read_b128 v[232:235], v153 offset:7488
    ds_read_b128 v[136:139], v152 offset:0
    ds_read_b128 v[140:143], v152 offset:416
    ds_read_b128 v[144:147], v152 offset:832
    ds_read_b128 v[148:151], v152 offset:4160
    ds_read_b128 v[236:239], v153 offset:7520
    buffer_load_dwordx4 v13, s[32:35], s18 offen offset:1024 lds
    ds_read_b128 v[180:183], v152 offset:32
    s_waitcnt lgkmcnt(6)
    v_mfma_f32_16x16x32_bf16 v[92:95], v[20:23], v[232:235], 0
    s_waitcnt lgkmcnt(4)
    ds_read_b128 v[184:187], v152 offset:448
    ds_read_b128 v[188:191], v152 offset:864
    ds_read_b128 v[192:195], v152 offset:4192
    s_nop 1
    v_smfmac_f32_16x16x64_bf16 v[92:95], v[68:71], v[136:143], v19
    s_waitcnt lgkmcnt(5)
    buffer_load_dwordx4 v14, s[32:35], s18 offen offset:2048 lds
    v_smfmac_f32_16x16x64_bf16 v[92:95], v[72:75], v[144:151], v19
    s_waitcnt lgkmcnt(4)
    ds_read_b128 v[176:179], v153 offset:7552
    ds_read_b128 v[128:131], v152 offset:64
    v_mfma_f32_16x16x32_bf16 v[96:99], v[24:27], v[236:239], 0
    s_waitcnt lgkmcnt(4)
    ds_read_b128 v[132:135], v152 offset:480
    ds_read_b128 v[136:139], v152 offset:896
    s_nop 1
    v_add_f32 v158, v92, v93
    v_mul_f32 v159, v92, v92
    v_smfmac_f32_16x16x64_bf16 v[96:99], v[76:79], v[180:187], v19
    s_waitcnt lgkmcnt(4)
    ds_read_b128 v[140:143], v152 offset:4224
    ds_read_b128 v[164:167], v172 offset:1024
    s_add_u32 m0, s56, 39936
    s_mov_b32 s18, 147456
    buffer_load_dwordx4 v12, s[32:35], s18 offen offset:0 lds
    v_smfmac_f32_16x16x64_bf16 v[96:99], v[80:83], v[188:195], v19
    s_waitcnt lgkmcnt(5)
    ds_read_b128 v[168:171], v172 offset:1040
    ds_read_b128 v[220:223], v7 offset:43776
    v_mfma_f32_16x16x32_bf16 v[100:103], v[28:31], v[176:179], 0
    s_waitcnt lgkmcnt(5)
    v_fmac_f32 v159, v93, v93
    v_add_f32 v158, v158, v94
    v_fmac_f32 v159, v94, v94
    v_add_f32 v158, v158, v95
    v_fmac_f32 v159, v95, v95
    v_add_f32 v158, v158, v96
    v_smfmac_f32_16x16x64_bf16 v[100:103], v[84:87], v[128:135], v19
    s_waitcnt lgkmcnt(3)
    ds_read_b128 v[224:227], v7 offset:44800
    ds_read_b128 v[228:231], v7 offset:45824
    buffer_load_dwordx4 v13, s[32:35], s18 offen offset:1024 lds
    v_smfmac_f32_16x16x64_bf16 v[100:103], v[88:91], v[136:143], v19
    s_waitcnt vmcnt(11)
    ds_read_b64_tr_b16 a[72:73], v18 offset:0
    ds_read_b64_tr_b16 a[96:97], v18 offset:32
    ds_read_b64_tr_b16 a[120:121], v18 offset:64
    ds_read_b64_tr_b16 a[74:75], v18 offset:1536
    s_waitcnt lgkmcnt(8)
    v_add_f32 v164, v164, v165
    v_add_f32 v166, v166, v167
    s_waitcnt lgkmcnt(7)
    v_add_f32 v168, v168, v169
    v_add_f32 v170, v170, v171
    s_waitcnt lgkmcnt(6)
    v_mfma_f32_16x16x32_bf16 v[208:211], a[0:3], v[220:223], 0
    ds_read_b64_tr_b16 a[98:99], v18 offset:1568
    ds_read_b64_tr_b16 a[122:123], v18 offset:1600
    v_mfma_f32_16x16x32_bf16 v[212:215], a[24:27], v[220:223], 0
    s_waitcnt lgkmcnt(7)
    buffer_load_dwordx4 v14, s[32:35], s18 offen offset:2048 lds
    v_mfma_f32_16x16x32_bf16 v[208:211], a[4:7], v[224:227], v[208:211]
    s_waitcnt lgkmcnt(6)
    v_add_f32 v164, v164, v166
    v_add_f32 v168, v168, v170
    v_mfma_f32_16x16x32_bf16 v[208:211], a[8:11], v[228:231], v[208:211]
    s_waitcnt vmcnt(9)
    ds_read_b64_tr_b16 a[88:89], v18 offset:3072
    ds_read_b64_tr_b16 a[112:113], v18 offset:3104
    v_mfma_f32_16x16x32_bf16 v[212:215], a[28:31], v[224:227], v[212:215]
    ds_read_b64_tr_b16 a[136:137], v18 offset:3136
    ds_read_b64_tr_b16 a[76:77], v18 offset:4608
    v_mfma_f32_16x16x32_bf16 v[212:215], a[32:35], v[228:231], v[212:215]
    ds_read_b64_tr_b16 a[100:101], v18 offset:4640
    ds_read_b64_tr_b16 a[124:125], v18 offset:4672
    v_mfma_f32_16x16x32_bf16 v[216:219], a[48:51], v[220:223], 0
    s_add_u32 m0, s56, 43008
    s_mov_b32 s18, 184320
    buffer_load_dwordx4 v12, s[32:35], s18 offen offset:0 lds
    v_mfma_f32_16x16x32_bf16 v[216:219], a[52:55], v[224:227], v[216:219]
    ds_read_b128 v[220:223], v7 offset:46848
    ds_read_b128 v[224:227], v7 offset:47872
    v_mfma_f32_16x16x32_bf16 v[216:219], a[56:59], v[228:231], v[216:219]
    ds_read_b128 v[228:231], v7 offset:48896
    v_mul_f32 v164, s59, v164
    v_fma_f32 v165, v164, v164, -s60
    v_fma_f32 v168, v168, s59, -v165
    v_max_f32 v168, s60, v168
    v_rsq_f32 v250, v168
    v_fmac_f32 v159, v96, v96
    buffer_load_dwordx4 v13, s[32:35], s18 offen offset:1024 lds
    v_mul_f32 v251, v164, v250
    v_fma_f32 v246, v32, v250, -v251
    v_fma_f32 v247, v33, v250, -v251
    v_cvt_pk_bf16_f32 v240, v246, v247
    v_fma_f32 v246, v34, v250, -v251
    v_fma_f32 v247, v35, v250, -v251
    s_waitcnt lgkmcnt(2)
    v_mfma_f32_16x16x32_bf16 v[216:219], a[60:63], v[220:223], v[216:219]
    s_waitcnt lgkmcnt(1)
    v_cvt_pk_bf16_f32 v241, v246, v247
    v_fma_f32 v246, v36, v250, -v251
    v_mfma_f32_16x16x32_bf16 v[216:219], a[64:67], v[224:227], v[216:219]
    s_waitcnt lgkmcnt(0)
    v_fma_f32 v247, v37, v250, -v251
    v_cvt_pk_bf16_f32 v242, v246, v247
    v_mfma_f32_16x16x32_bf16 v[216:219], a[68:71], v[228:231], v[216:219]
    buffer_load_dwordx4 v14, s[32:35], s18 offen offset:2048 lds
    v_mfma_f32_16x16x32_bf16 v[212:215], a[36:39], v[220:223], v[212:215]
    s_waitcnt vmcnt(9)
    ds_read_b64_tr_b16 a[78:79], v18 offset:6144
    ds_read_b64_tr_b16 a[102:103], v18 offset:6176
    v_mfma_f32_16x16x32_bf16 v[212:215], a[40:43], v[224:227], v[212:215]
    ds_read_b64_tr_b16 a[126:127], v18 offset:6208
    ds_read_b64_tr_b16 a[90:91], v18 offset:7680
    v_mfma_f32_16x16x32_bf16 v[212:215], a[44:47], v[228:231], v[212:215]
    ds_read_b64_tr_b16 a[114:115], v18 offset:7712
    ds_read_b64_tr_b16 a[138:139], v18 offset:7744
    v_mfma_f32_16x16x32_bf16 v[208:211], a[12:15], v[220:223], v[208:211]
    v_fma_f32 v246, v38, v250, -v251
    v_fma_f32 v247, v39, v250, -v251
    v_mfma_f32_16x16x32_bf16 v[208:211], a[16:19], v[224:227], v[208:211]
    s_add_u32 m0, s56, 0
    s_mov_b32 s18, 768
    buffer_load_dwordx4 v12, s[32:35], s18 offen offset:0 lds
    v_mfma_f32_16x16x32_bf16 v[208:211], a[20:23], v[228:231], v[208:211]
    v_cvt_pk_bf16_f32 v243, v246, v247
    v_fma_f32 v246, v40, v250, -v251
    v_fma_f32 v247, v41, v250, -v251
    v_cvt_pk_bf16_f32 v244, v246, v247
    v_fma_f32 v246, v42, v250, -v251
    v_fma_f32 v247, v43, v250, -v251
    v_cvt_pk_bf16_f32 v245, v246, v247
    ds_write_b128 v8, v[240:243] offset:37632
    v_add_f32 v158, v158, v97
    v_fmac_f32 v159, v97, v97
    v_add_f32 v158, v158, v98
    v_fmac_f32 v159, v98, v98
    v_add_f32 v158, v158, v99
    v_fmac_f32 v159, v99, v99
    v_add_f32 v158, v158, v100
    v_fmac_f32 v159, v100, v100
    v_add_f32 v158, v158, v101
    v_fmac_f32 v159, v101, v101
    v_add_f32 v158, v158, v102
    v_fmac_f32 v159, v102, v102
    v_add_f32 v158, v158, v103
    v_fmac_f32 v159, v103, v103
    v_cvt_pk_bf16_f32 v110, v208, v209
    ds_write_b64 v9, v[244:245] offset:37632
    v_permlane16_swap_b32 v158, v159
    v_add_f32 v158, v158, v159
    v_mov_b32 v160, v158
    v_cvt_pk_bf16_f32 v111, v210, v211
    v_cvt_pk_bf16_f32 v112, v212, v213
    v_permlane32_swap_b32 v158, v160
    v_add_f32 v158, v158, v160
    v_cvt_pk_bf16_f32 v113, v214, v215
    v_cvt_pk_bf16_f32 v114, v216, v217
    v_cvt_pk_bf16_f32 v115, v218, v219
    v_lshlrev_b32 v172, 3, v11
    v_add_u32 v172, 158208, v172
    buffer_load_dwordx4 v13, s[32:35], s18 offen offset:1024 lds
    ds_write_b32 v10, v158 offset:0
    v_subrev_u32 v250, 93184, v7
    v_mul_u32_u24 v250, 10923, v250
    v_lshrrev_b32 v250, 20, v250
    v_mul_u32_u24 v250, 768, v250
    buffer_load_dwordx4 v14, s[32:35], s18 offen offset:2048 lds
    s_waitcnt vmcnt(9)
    ds_read_b64_tr_b16 a[80:81], v18 offset:36864
    s_waitcnt lgkmcnt(1)
    s_barrier
    ds_read_b128 v[164:167], v172 offset:0
    ds_read_b128 v[168:171], v172 offset:16
    ds_read_b128 v[220:223], v7 offset:37632
    ds_read_b128 v[224:227], v7 offset:38656
    s_add_u32 m0, s56, 3072
    s_mov_b32 s18, 37632
    buffer_load_dwordx4 v12, s[32:35], s18 offen offset:0 lds
    ds_read_b128 v[228:231], v7 offset:39680
    ds_read_b64_tr_b16 a[104:105], v18 offset:36896
    ds_read_b64_tr_b16 a[128:129], v18 offset:36928
    ds_read_b64_tr_b16 a[82:83], v18 offset:38400
    ds_read_b64_tr_b16 a[106:107], v18 offset:38432
    s_waitcnt lgkmcnt(8)
    v_add_f32 v164, v164, v165
    v_add_f32 v166, v166, v167
    v_add_f32 v164, v164, v166
    s_waitcnt lgkmcnt(7)
    v_add_f32 v168, v168, v169
    v_add_f32 v170, v170, v171
    v_add_f32 v168, v168, v170
    s_waitcnt lgkmcnt(6)
    v_mfma_f32_16x16x32_bf16 v[196:199], a[0:3], v[220:223], 0
    s_waitcnt lgkmcnt(5)
    buffer_load_dwordx4 v13, s[32:35], s18 offen offset:1024 lds
    v_mfma_f32_16x16x32_bf16 v[196:199], a[4:7], v[224:227], v[196:199]
    s_waitcnt lgkmcnt(4)
    ds_read_b64_tr_b16 a[130:131], v18 offset:38464
    ds_read_b128 v[232:235], v7 offset:40704
    v_mfma_f32_16x16x32_bf16 v[196:199], a[8:11], v[228:231], v[196:199]
    ds_read_b128 v[236:239], v7 offset:41728
    v_mul_f32 v164, s59, v164
    v_mfma_f32_16x16x32_bf16 v[200:203], a[24:27], v[220:223], 0
    v_fma_f32 v165, v164, v164, -s60
    v_fma_f32 v168, v168, s59, -v165
    v_mfma_f32_16x16x32_bf16 v[200:203], a[28:31], v[224:227], v[200:203]
    v_max_f32 v168, s60, v168
    v_rsq_f32 v248, v168
    v_mfma_f32_16x16x32_bf16 v[200:203], a[32:35], v[228:231], v[200:203]
    buffer_load_dwordx4 v14, s[32:35], s18 offen offset:2048 lds
    v_mfma_f32_16x16x32_bf16 v[204:207], a[48:51], v[220:223], 0
    s_waitcnt vmcnt(9)
    ds_read_b128 v[220:223], v7 offset:40704
    ds_read_b64_tr_b16 a[92:93], v18 offset:39936
    v_mfma_f32_16x16x32_bf16 v[204:207], a[52:55], v[224:227], v[204:207]
    ds_read_b128 v[224:227], v7 offset:41728
    ds_read_b64_tr_b16 a[116:117], v18 offset:39968
    v_mfma_f32_16x16x32_bf16 v[204:207], a[56:59], v[228:231], v[204:207]
    ds_read_b128 v[228:231], v7 offset:42752
    v_cndmask_b32_e64 v248, 0, v248, vcc
    ds_read_b64_tr_b16 a[140:141], v18 offset:40000
    ds_read_b64_tr_b16 a[84:85], v18 offset:41472
    s_add_u32 m0, s56, 6144
    s_mov_b32 s18, 74496
    buffer_load_dwordx4 v12, s[32:35], s18 offen offset:0 lds
    ds_read_b64_tr_b16 a[108:109], v18 offset:41504
    ds_read_b64_tr_b16 a[132:133], v18 offset:41536
    s_waitcnt lgkmcnt(8)
    v_mfma_f32_16x16x32_bf16 v[204:207], a[60:63], v[220:223], v[204:207]
    s_mov_b64 vcc, 0
    v_mul_f32 v249, v164, v248
    v_fma_f32 v246, v92, v248, -v249
    v_mfma_f32_16x16x32_bf16 v[200:203], a[36:39], v[220:223], v[200:203]
    s_mov_b32 vcc_lo, 0xffff
    v_fma_f32 v247, v93, v248, -v249
    v_cvt_pk_bf16_f32 v240, v246, v247
    s_waitcnt lgkmcnt(6)
    v_mfma_f32_16x16x32_bf16 v[204:207], a[64:67], v[224:227], v[204:207]
    s_waitcnt lgkmcnt(4)
    v_fma_f32 v246, v94, v248, -v249
    v_fma_f32 v247, v95, v248, -v249
    v_mfma_f32_16x16x32_bf16 v[204:207], a[68:71], v[228:231], v[204:207]
    buffer_load_dwordx4 v13, s[32:35], s18 offen offset:1024 lds
    v_mfma_f32_16x16x32_bf16 v[200:203], a[40:43], v[224:227], v[200:203]
    v_cvt_pk_bf16_f32 v241, v246, v247
    v_fma_f32 v246, v96, v248, -v249
    v_mfma_f32_16x16x32_bf16 v[200:203], a[44:47], v[228:231], v[200:203]
    v_fma_f32 v247, v97, v248, -v249
    v_cvt_pk_bf16_f32 v242, v246, v247
    v_mfma_f32_16x16x32_bf16 v[196:199], a[12:15], v[220:223], v[196:199]
    ds_read_b128 v[220:223], v7 offset:37632
    v_fma_f32 v246, v98, v248, -v249
    v_mfma_f32_16x16x32_bf16 v[196:199], a[16:19], v[224:227], v[196:199]
    s_waitcnt vmcnt(8)
    ds_read_b128 v[224:227], v7 offset:38656
    ds_read_b64_tr_b16 a[86:87], v18 offset:43008
    v_mfma_f32_16x16x32_bf16 v[196:199], a[20:23], v[228:231], v[196:199]
    buffer_load_dwordx4 v14, s[32:35], s18 offen offset:2048 lds
    ds_read_b64_tr_b16 a[110:111], v18 offset:43040
    ds_read_b64_tr_b16 a[134:135], v18 offset:43072
    ds_read_b64_tr_b16 a[94:95], v18 offset:44544
    ds_read_b64_tr_b16 a[118:119], v18 offset:44576
    ds_read_b64_tr_b16 a[142:143], v18 offset:44608
    ds_read_b128 v[228:231], v7 offset:39680
    v_fma_f32 v247, v99, v248, -v249
    v_cvt_pk_bf16_f32 v243, v246, v247
    v_fma_f32 v246, v100, v248, -v249
    v_fma_f32 v247, v101, v248, -v249
    v_cvt_pk_bf16_f32 v244, v246, v247
    v_fma_f32 v246, v102, v248, -v249
    s_waitcnt lgkmcnt(8)
    v_mfma_f32_16x16x32_bf16 v[208:211], a[72:75], v[220:223], 0
    s_waitcnt lgkmcnt(7)
    ds_write_b128 v8, v[240:243] offset:56832
    v_mfma_f32_16x16x32_bf16 v[208:211], a[76:79], v[224:227], v[208:211]
    s_add_u32 m0, s56, 36864
    s_mov_b32 s18, 111360
    buffer_load_dwordx4 v12, s[32:35], s18 offen offset:0 lds
    v_mfma_f32_16x16x32_bf16 v[212:215], a[96:99], v[220:223], 0
    s_waitcnt lgkmcnt(1)
    v_fma_f32 v247, v103, v248, -v249
    v_cvt_pk_bf16_f32 v245, v246, v247
    v_mfma_f32_16x16x32_bf16 v[208:211], a[80:83], v[228:231], v[208:211]
    v_cvt_pk_bf16_f32 v104, v196, v197
    v_cvt_pk_bf16_f32 v105, v198, v199
    v_mfma_f32_16x16x32_bf16 v[212:215], a[100:103], v[224:227], v[212:215]
    v_cvt_pk_bf16_f32 v106, v200, v201
    v_cvt_pk_bf16_f32 v107, v202, v203
    v_mfma_f32_16x16x32_bf16 v[212:215], a[104:107], v[228:231], v[212:215]
    ds_write_b64 v9, v[244:245] offset:56832
    v_mfma_f32_16x16x32_bf16 v[216:219], a[120:123], v[220:223], 0
    buffer_load_dwordx4 v13, s[32:35], s18 offen offset:1024 lds
    v_mfma_f32_16x16x32_bf16 v[216:219], a[124:127], v[224:227], v[216:219]
    ds_read_b128 v[220:223], v7 offset:42752
    v_cvt_pk_bf16_f32 v108, v204, v205
    v_mfma_f32_16x16x32_bf16 v[216:219], a[128:131], v[228:231], v[216:219]
    v_cvt_pk_bf16_f32 v109, v206, v207
    v_subrev_u32 v248, 95232, v7
    v_mfma_f32_16x16x32_bf16 v[216:219], a[132:135], v[232:235], v[216:219]
    v_mul_u32_u24 v248, 10923, v248
    v_lshrrev_b32 v248, 20, v248
    v_mfma_f32_16x16x32_bf16 v[216:219], a[136:139], v[236:239], v[216:219]
    v_mul_u32_u24 v248, 768, v248
    v_subrev_u32 v249, 94208, v7
    v_mfma_f32_16x16x32_bf16 v[212:215], a[108:111], v[232:235], v[212:215]
    s_waitcnt lgkmcnt(1)
    s_barrier
    v_mfma_f32_16x16x32_bf16 v[212:215], a[112:115], v[236:239], v[212:215]
    s_waitcnt lgkmcnt(0)
    buffer_load_dwordx4 v14, s[32:35], s18 offen offset:2048 lds
    v_mfma_f32_16x16x32_bf16 v[216:219], a[140:143], v[220:223], v[216:219]
    ds_read_b128 v[224:227], v7 offset:56832
    ds_read_b128 v[228:231], v7 offset:57856
    v_mfma_f32_16x16x32_bf16 v[212:215], a[116:119], v[220:223], v[212:215]
    v_mul_u32_u24 v249, 10923, v249
    v_lshrrev_b32 v249, 20, v249
    v_mfma_f32_16x16x32_bf16 v[208:211], a[84:87], v[232:235], v[208:211]
    ds_read_b128 v[232:235], v7 offset:58880
    v_mul_u32_u24 v249, 768, v249
    v_mfma_f32_16x16x32_bf16 v[208:211], a[88:91], v[236:239], v[208:211]
    ds_read_b128 v[236:239], v7 offset:59904
    v_cvt_pk_bf16_f32 v162, v216, v217
    v_mfma_f32_16x16x32_bf16 v[208:211], a[92:95], v[220:223], v[208:211]
    s_waitcnt vmcnt(9)
    s_add_u32 m0, s56, 39936
    s_mov_b32 s18, 148224
    buffer_load_dwordx4 v12, s[32:35], s18 offen offset:0 lds
    ds_read_b64_tr_b16 a[144:145], v18 offset:0
    ds_read_b64_tr_b16 a[168:169], v18 offset:32
    s_waitcnt lgkmcnt(5)
    v_mfma_f32_16x16x32_bf16 v[196:199], a[0:3], v[224:227], 0
    s_waitcnt lgkmcnt(4)
    ds_read_b64_tr_b16 a[192:193], v18 offset:64
    ds_read_b64_tr_b16 a[146:147], v18 offset:1536
    v_mfma_f32_16x16x32_bf16 v[196:199], a[4:7], v[228:231], v[196:199]
    s_waitcnt lgkmcnt(5)
    ds_read_b64_tr_b16 a[170:171], v18 offset:1568
    ds_read_b64_tr_b16 a[194:195], v18 offset:1600
    v_mfma_f32_16x16x32_bf16 v[196:199], a[8:11], v[232:235], v[196:199]
    ds_read_b128 v[220:223], v7 offset:60928
    buffer_load_dwordx4 v13, s[32:35], s18 offen offset:1024 lds
    v_mfma_f32_16x16x32_bf16 v[200:203], a[24:27], v[224:227], 0
    v_cvt_pk_bf16_f32 v158, v208, v209
    v_cvt_pk_bf16_f32 v159, v210, v211
    v_mfma_f32_16x16x32_bf16 v[200:203], a[28:31], v[228:231], v[200:203]
    v_cvt_pk_bf16_f32 v160, v212, v213
    v_cvt_pk_bf16_f32 v161, v214, v215
    v_mfma_f32_16x16x32_bf16 v[200:203], a[32:35], v[232:235], v[200:203]
    v_cvt_pk_bf16_f32 v163, v218, v219
    v_cndmask_b32_e64 v0, v0, 0, vcc
    v_mfma_f32_16x16x32_bf16 v[204:207], a[48:51], v[224:227], 0
    ds_read_b128 v[224:227], v7 offset:61952
    ds_write_b128 v15, v[92:95] offset:0
    v_mfma_f32_16x16x32_bf16 v[204:207], a[52:55], v[228:231], v[204:207]
    buffer_load_dwordx4 v14, s[32:35], s18 offen offset:2048 lds
    v_mfma_f32_16x16x32_bf16 v[204:207], a[56:59], v[232:235], v[204:207]
    s_waitcnt lgkmcnt(9)
    ds_read_b128 v[228:231], v7 offset:56832
    v_mfma_f32_16x16x32_bf16 v[204:207], a[60:63], v[236:239], v[204:207]
    s_waitcnt lgkmcnt(3)
    ds_read_b128 v[232:235], v7 offset:57856
    v_mfma_f32_16x16x32_bf16 v[204:207], a[64:67], v[220:223], v[204:207]
    s_waitcnt lgkmcnt(3)
    v_mfma_f32_16x16x32_bf16 v[204:207], a[68:71], v[224:227], v[204:207]
    ds_write_b128 v15, v[96:99] offset:256
    v_mfma_f32_16x16x32_bf16 v[200:203], a[36:39], v[236:239], v[200:203]
    s_add_u32 m0, s56, 43008
    s_mov_b32 s18, 185088
    buffer_load_dwordx4 v12, s[32:35], s18 offen offset:0 lds
    v_mfma_f32_16x16x32_bf16 v[200:203], a[40:43], v[220:223], v[200:203]
    s_waitcnt vmcnt(10)
    ds_read_b64_tr_b16 a[160:161], v18 offset:3072
    ds_read_b64_tr_b16 a[184:185], v18 offset:3104
    v_mfma_f32_16x16x32_bf16 v[200:203], a[44:47], v[224:227], v[200:203]
    ds_read_b64_tr_b16 a[208:209], v18 offset:3136
    ds_read_b64_tr_b16 a[148:149], v18 offset:4608
    v_mfma_f32_16x16x32_bf16 v[196:199], a[12:15], v[236:239], v[196:199]
    ds_read_b64_tr_b16 a[172:173], v18 offset:4640
    ds_read_b64_tr_b16 a[196:197], v18 offset:4672
    v_mfma_f32_16x16x32_bf16 v[196:199], a[16:19], v[220:223], v[196:199]
    ds_read_b128 v[236:239], v7 offset:58880
    ds_read_b128 v[220:223], v7 offset:59904
    v_mfma_f32_16x16x32_bf16 v[196:199], a[20:23], v[224:227], v[196:199]
    s_waitcnt lgkmcnt(10)
    buffer_load_dwordx4 v13, s[32:35], s18 offen offset:1024 lds
    v_mfma_f32_16x16x32_bf16 v[208:211], a[72:75], v[228:231], 0
    s_waitcnt lgkmcnt(9)
    ds_read_b128 v[224:227], v7 offset:60928
    v_sub_u32 v12, v12, v248
    v_mfma_f32_16x16x32_bf16 v[208:211], a[76:79], v[232:235], v[208:211]
    v_sub_u32 v13, v13, v249
    v_cvt_pk_bf16_f32 v122, v196, v197
    v_mfma_f32_16x16x32_bf16 v[212:215], a[96:99], v[228:231], 0
    s_waitcnt lgkmcnt(2)
    ds_write_b128 v15, v[100:103] offset:512
    v_mfma_f32_16x16x32_bf16 v[208:211], a[80:83], v[236:239], v[208:211]
    buffer_load_dwordx4 v14, s[32:35], s18 offen offset:2048 lds
    v_mfma_f32_16x16x32_bf16 v[212:215], a[100:103], v[232:235], v[212:215]
    v_sub_u32 v14, v14, v250
    v_cvt_pk_bf16_f32 v123, v198, v199
    v_mfma_f32_16x16x32_bf16 v[212:215], a[104:107], v[236:239], v[212:215]
    v_cvt_pk_bf16_f32 v124, v200, v201
    v_cvt_pk_bf16_f32 v125, v202, v203
    v_mfma_f32_16x16x32_bf16 v[216:219], a[120:123], v[228:231], 0
    s_waitcnt vmcnt(9)
    ds_read_b128 v[228:231], v7 offset:61952
    ds_read_b64_tr_b16 a[150:151], v18 offset:6144
    v_mfma_f32_16x16x32_bf16 v[216:219], a[124:127], v[232:235], v[216:219]
    ds_read_b64_tr_b16 a[174:175], v18 offset:6176
    ds_read_b64_tr_b16 a[198:199], v18 offset:6208
    v_mfma_f32_16x16x32_bf16 v[216:219], a[128:131], v[236:239], v[216:219]
    s_waitcnt lgkmcnt(6)
    s_add_u32 m0, s79, 0
    s_add_u32 s18, s89, 0
    buffer_load_dwordx4 v16, s[24:27], s18 offen nt lds
    v_mfma_f32_16x16x32_bf16 v[216:219], a[132:135], v[220:223], v[216:219]
    s_waitcnt lgkmcnt(5)
    ds_read_b64_tr_b16 a[162:163], v18 offset:7680
    ds_read_b64_tr_b16 a[186:187], v18 offset:7712
    v_mfma_f32_16x16x32_bf16 v[216:219], a[136:139], v[224:227], v[216:219]
    ds_read_b64_tr_b16 a[210:211], v18 offset:7744
    ds_read_b128 v[232:235], v7 offset:56832
    v_mfma_f32_16x16x32_bf16 v[212:215], a[108:111], v[220:223], v[212:215]
    s_waitcnt lgkmcnt(7)
    ds_read_b128 v[236:239], v7 offset:57856
    ds_write_b128 v17, v[68:71] offset:0
    v_mfma_f32_16x16x32_bf16 v[216:219], a[140:143], v[228:231], v[216:219]
    s_add_u32 m0, s79, 3744
    s_add_u32 s18, s89, 86016
    buffer_load_dwordx4 v16, s[20:23], s18 offen nt lds
    v_mfma_f32_16x16x32_bf16 v[212:215], a[112:115], v[224:227], v[212:215]
    v_cvt_pk_bf16_f32 v126, v204, v205
    v_cvt_pk_bf16_f32 v127, v206, v207
    v_mfma_f32_16x16x32_bf16 v[212:215], a[116:119], v[228:231], v[212:215]
    v_lshl_add_u32 v248, v7, 1, s19
    v_mfma_f32_16x16x32_bf16 v[208:211], a[84:87], v[220:223], v[208:211]
    ds_read_b128 v[220:223], v7 offset:58880
    ds_write_b128 v17, v[72:75] offset:1024
    v_mfma_f32_16x16x32_bf16 v[208:211], a[88:91], v[224:227], v[208:211]
    s_add_u32 m0, s79, 7488
    s_add_u32 s18, s89, 172032
    buffer_load_dwordx4 v16, s[20:23], s18 offen nt lds
    v_mfma_f32_16x16x32_bf16 v[208:211], a[92:95], v[228:231], v[208:211]
    ds_read_b128 v[224:227], v7 offset:59904
    ds_read_b128 v[228:231], v7 offset:60928
    v_mfma_f32_16x16x32_bf16 v[180:183], v[104:107], v[158:161], 0
    v_cvt_pk_bf16_f32 v154, v212, v213
    v_cvt_pk_bf16_f32 v155, v214, v215
    v_mfma_f32_16x16x32_bf16 v[184:187], v[110:113], v[158:161], 0
    v_cvt_pk_bf16_f32 v156, v216, v217
    v_cvt_pk_bf16_f32 v157, v218, v219
    v_mfma_f32_16x16x32_bf16 v[188:191], v[116:119], v[158:161], 0
    ds_write_b128 v17, v[76:79] offset:2048
    v_mfma_f32_16x16x32_bf16 v[192:195], v[122:125], v[158:161], v[0:3]
    s_add_u32 m0, s79, 11232
    s_add_u32 s18, s89, 258048
    buffer_load_dwordx4 v16, s[20:23], s18 offen nt lds
    v_mfma_f32_16x16x16_bf16 v[180:183], v[108:109], v[162:163], v[180:183]
    s_waitcnt vmcnt(10)
    ds_read_b64_tr_b16 a[152:153], v18 offset:36864
    ds_read_b64_tr_b16 a[176:177], v18 offset:36896
    v_mfma_f32_16x16x16_bf16 v[184:187], v[114:115], v[162:163], v[184:187]
    ds_read_b64_tr_b16 a[200:201], v18 offset:36928
    ds_read_b64_tr_b16 a[154:155], v18 offset:38400
    v_mfma_f32_16x16x16_bf16 v[188:191], v[120:121], v[162:163], v[188:191]
    ds_read_b64_tr_b16 a[178:179], v18 offset:38432
    ds_read_b64_tr_b16 a[202:203], v18 offset:38464
    v_mfma_f32_16x16x16_bf16 v[192:195], v[126:127], v[162:163], v[192:195]
    s_waitcnt lgkmcnt(13)
    ds_write_b128 v17, v[80:83] offset:3072
    v_mfma_f32_16x16x32_bf16 v[196:199], v[232:235], a[144:147], 0
    s_waitcnt lgkmcnt(13)
    s_add_u32 m0, s79, 14976
    s_add_u32 s18, s89, 344064
    buffer_load_dwordx4 v16, s[20:23], s18 offen nt lds
    v_mfma_f32_16x16x32_bf16 v[196:199], v[236:239], a[148:151], v[196:199]
    s_waitcnt lgkmcnt(3)
    v_cvt_pk_bf16_f32 v152, v208, v209
    v_cvt_pk_bf16_f32 v153, v210, v211
    v_mfma_f32_16x16x32_bf16 v[196:199], v[220:223], a[152:155], v[196:199]
    v_max3_f32 v254, v180, v181, v182
    v_max3_f32 v255, v183, v184, v185
    v_mfma_f32_16x16x32_bf16 v[164:167], v[104:107], v[152:155], 0
    v_max3_f32 v254, v254, v186, v187
    v_max3_f32 v255, v255, v188, v189
    v_mfma_f32_16x16x32_bf16 v[168:171], v[110:113], v[152:155], 0
    ds_write_b128 v17, v[84:87] offset:4096
    v_mfma_f32_16x16x32_bf16 v[172:175], v[116:119], v[152:155], 0
    s_add_u32 m0, s79, 18720
    s_add_u32 s18, s89, 430080
    buffer_load_dwordx4 v16, s[20:23], s18 offen nt lds
    v_mfma_f32_16x16x32_bf16 v[176:179], v[122:125], v[152:155], v[0:3]
    s_waitcnt vmcnt(9)
    ds_read_b64_tr_b16 a[164:165], v18 offset:39936
    v_mfma_f32_16x16x16_bf16 v[164:167], v[108:109], v[156:157], v[164:167]
    ds_read_b64_tr_b16 a[188:189], v18 offset:39968
    ds_read_b64_tr_b16 a[212:213], v18 offset:40000
    v_mfma_f32_16x16x16_bf16 v[168:171], v[114:115], v[156:157], v[168:171]
    ds_read_b64_tr_b16 a[156:157], v18 offset:41472
    ds_read_b64_tr_b16 a[180:181], v18 offset:41504
    v_mfma_f32_16x16x16_bf16 v[172:175], v[120:121], v[156:157], v[172:175]
    ds_read_b64_tr_b16 a[204:205], v18 offset:41536
    ds_write_b128 v17, v[88:91] offset:5120
    v_mfma_f32_16x16x16_bf16 v[176:179], v[126:127], v[156:157], v[176:179]
    s_add_u32 m0, s79, 22464
    s_add_u32 s18, s89, 516096
    buffer_load_dwordx4 v16, s[20:23], s18 offen nt lds
    v_mfma_f32_16x16x32_bf16 v[200:203], v[232:235], a[168:171], 0
    v_max3_f32 v252, v164, v165, v166
    v_max3_f32 v253, v167, v168, v169
    v_mfma_f32_16x16x32_bf16 v[200:203], v[236:239], a[172:175], v[200:203]
    s_waitcnt lgkmcnt(10)
    v_max3_f32 v252, v252, v170, v171
    v_max3_f32 v253, v253, v172, v173
    v_mfma_f32_16x16x32_bf16 v[200:203], v[220:223], a[176:179], v[200:203]
    v_max3_f32 v252, v252, v174, v175
    v_max3_f32 v252, v252, v253, v176
    v_mfma_f32_16x16x32_bf16 v[204:207], v[232:235], a[192:195], 0
    ds_read_b128 v[232:235], v7 offset:61952
    s_add_u32 m0, s79, 26208
    s_add_u32 s18, s89, 602112
    buffer_load_dwordx4 v16, s[20:23], s18 offen nt lds
    v_mfma_f32_16x16x32_bf16 v[204:207], v[236:239], a[196:199], v[204:207]
    s_waitcnt lgkmcnt(10)
    ds_read_b128 v[236:239], v7 offset:37632
    v_mov_b32 v253, v252
    v_mfma_f32_16x16x32_bf16 v[204:207], v[220:223], a[200:203], v[204:207]
    ds_read_b128 v[220:223], v7 offset:38656
    v_permlane16_swap_b32 v252, v253
    v_max_f32 v252, v252, v253
    v_mov_b32 v253, v252
    v_max3_f32 v254, v254, v190, v191
    v_max3_f32 v254, v254, v255, v192
    v_permlane32_swap_b32 v252, v253
    s_add_u32 m0, s79, 29952
    s_add_u32 s18, s89, 688128
    buffer_load_dwordx4 v16, s[28:31], s18 offen nt lds
    s_waitcnt vmcnt(9)
    ds_read_b64_tr_b16 a[158:159], v18 offset:43008
    s_waitcnt lgkmcnt(2)
    v_mfma_f32_16x16x32_bf16 v[208:211], v[236:239], a[144:147], 0
    s_waitcnt lgkmcnt(1)
    ds_read_b64_tr_b16 a[182:183], v18 offset:43040
    ds_read_b64_tr_b16 a[206:207], v18 offset:43072
    v_mfma_f32_16x16x32_bf16 v[208:211], v[220:223], a[148:151], v[208:211]
    ds_read_b64_tr_b16 a[166:167], v18 offset:44544
    ds_read_b64_tr_b16 a[190:191], v18 offset:44576
    v_mfma_f32_16x16x32_bf16 v[212:215], v[236:239], a[168:171], 0
    ds_read_b64_tr_b16 a[214:215], v18 offset:44608
    s_add_u32 m0, s56, 0
    s_mov_b32 s18, 0
    buffer_load_dwordx4 v12, s[36:39], s18 offen offset:0 lds
    v_mfma_f32_16x16x32_bf16 v[212:215], v[220:223], a[172:175], v[212:215]
    s_waitcnt lgkmcnt(5)
    v_max_f32 v252, v252, v253
    v_mul_f32 v252, s54, v252
    v_mfma_f32_16x16x32_bf16 v[196:199], v[224:227], a[156:159], v[196:199]
    s_waitcnt lgkmcnt(3)
    s_andn2_b64 exec, -1, s[80:81]
    v_mov_b32 v252, 0x7f800000
    s_mov_b64 exec, -1
    v_mfma_f32_16x16x32_bf16 v[204:207], v[224:227], a[204:207], v[204:207]
    v_fma_f32 v164, v164, s54, -v252
    v_fma_f32 v165, v165, s54, -v252
    v_mfma_f32_16x16x32_bf16 v[204:207], v[228:231], a[208:211], v[204:207]
    s_waitcnt lgkmcnt(0)
    v_fma_f32 v166, v166, s54, -v252
    v_fma_f32 v167, v167, s54, -v252
    v_mfma_f32_16x16x32_bf16 v[204:207], v[232:235], a[212:215], v[204:207]
    v_fma_f32 v168, v168, s54, -v252
    v_fma_f32 v169, v169, s54, -v252
    v_mfma_f32_16x16x32_bf16 v[200:203], v[224:227], a[180:183], v[200:203]
    ds_read_b128 v[224:227], v7 offset:39680
    v_fma_f32 v170, v170, s54, -v252
    v_mfma_f32_16x16x32_bf16 v[200:203], v[228:231], a[184:187], v[200:203]
    v_fma_f32 v171, v171, s54, -v252
    v_fma_f32 v172, v172, s54, -v252
    v_mfma_f32_16x16x32_bf16 v[200:203], v[232:235], a[188:191], v[200:203]
    v_fma_f32 v173, v173, s54, -v252
    v_fma_f32 v174, v174, s54, -v252
    v_mfma_f32_16x16x32_bf16 v[196:199], v[228:231], a[160:163], v[196:199]
    ds_read_b128 v[228:231], v7 offset:40704
    v_fma_f32 v175, v175, s54, -v252
    v_mfma_f32_16x16x32_bf16 v[196:199], v[232:235], a[164:167], v[196:199]
    ds_read_b128 v[232:235], v7 offset:41728
    v_fma_f32 v176, v176, s54, -v252
    v_mfma_f32_16x16x32_bf16 v[216:219], v[236:239], a[192:195], 0
    s_waitcnt lgkmcnt(2)
    ds_read_b128 v[236:239], v7 offset:42752
    v_exp_f32 v164, v164
    v_mfma_f32_16x16x32_bf16 v[208:211], v[224:227], a[152:155], v[208:211]
    v_exp_f32 v165, v165
    v_mfma_f32_16x16x32_bf16 v[212:215], v[224:227], a[176:179], v[212:215]
    buffer_load_dwordx4 v13, s[36:39], s18 offen offset:1024 lds
    v_mfma_f32_16x16x32_bf16 v[216:219], v[220:223], a[196:199], v[216:219]
    ds_read_b128 v[220:223], v7 offset:43776
    v_exp_f32 v166, v166
    v_mfma_f32_16x16x32_bf16 v[216:219], v[224:227], a[200:203], v[216:219]
    s_waitcnt lgkmcnt(3)
    ds_read_b128 v[224:227], v7 offset:44800
    v_cvt_pk_bf16_f32 v164, v164, v165
    v_mfma_f32_16x16x32_bf16 v[216:219], v[228:231], a[204:207], v[216:219]
    s_waitcnt lgkmcnt(3)
    v_exp_f32 v167, v167
    v_mfma_f32_16x16x32_bf16 v[216:219], v[232:235], a[208:211], v[216:219]
    s_waitcnt lgkmcnt(2)
    v_exp_f32 v168, v168
    v_mfma_f32_16x16x32_bf16 v[216:219], v[236:239], a[212:215], v[216:219]
    v_cvt_pk_bf16_f32 v165, v166, v167
    v_exp_f32 v169, v169
    v_mfma_f32_16x16x32_bf16 v[212:215], v[228:231], a[180:183], v[212:215]
    buffer_load_dwordx4 v14, s[36:39], s18 offen offset:2048 lds
    v_mfma_f32_16x16x32_bf16 v[212:215], v[232:235], a[184:187], v[212:215]
    v_exp_f32 v170, v170
    v_mfma_f32_16x16x32_bf16 v[212:215], v[236:239], a[188:191], v[212:215]
    v_cvt_pk_bf16_f32 v166, v168, v169
    v_exp_f32 v171, v171
    v_mfma_f32_16x16x32_bf16 v[208:211], v[228:231], a[156:159], v[208:211]
    ds_read_b128 v[228:231], v7 offset:45824
    v_exp_f32 v172, v172
    v_mfma_f32_16x16x32_bf16 v[208:211], v[232:235], a[160:163], v[208:211]
    ds_read_b128 v[232:235], v7 offset:46848
    v_cvt_pk_bf16_f32 v167, v170, v171
    v_mfma_f32_16x16x32_bf16 v[208:211], v[236:239], a[164:167], v[208:211]
    s_waitcnt lgkmcnt(3)
    ds_read_b128 v[236:239], v7 offset:47872
    v_exp_f32 v173, v173
    v_exp_f32 v174, v174
    s_add_u32 m0, s56, 3072
    s_mov_b32 s18, 12288
    buffer_load_dwordx4 v12, s[36:39], s18 offen offset:0 lds
    v_cvt_pk_bf16_f32 v168, v172, v173
    v_exp_f32 v175, v175
    v_exp_f32 v176, v176
    v_cvt_pk_bf16_f32 v169, v174, v175
    v_mov_b32 v171, 0
    v_cvt_pk_bf16_f32 v170, v176, 0
    v_cvt_pk_bf16_f32 v134, v196, v197
    v_cvt_pk_bf16_f32 v135, v198, v199
    v_mfma_f32_16x16x32_bf16 v[196:199], v[220:223], a[144:147], 0
    s_waitcnt lgkmcnt(3)
    v_cvt_pk_bf16_f32 v142, v200, v201
    v_cvt_pk_bf16_f32 v143, v202, v203
    v_mfma_f32_16x16x32_bf16 v[196:199], v[224:227], a[148:151], v[196:199]
    s_waitcnt lgkmcnt(2)
    v_cvt_pk_bf16_f32 v150, v204, v205
    v_cvt_pk_bf16_f32 v151, v206, v207
    v_mfma_f32_16x16x32_bf16 v[196:199], v[228:231], a[152:155], v[196:199]
    buffer_load_dwordx4 v13, s[36:39], s18 offen offset:1024 lds
    v_mfma_f32_16x16x32_bf16 v[200:203], v[220:223], a[168:171], 0
    v_cvt_pk_bf16_f32 v128, v208, v209
    v_cvt_pk_bf16_f32 v129, v210, v211
    v_mfma_f32_16x16x32_bf16 v[200:203], v[224:227], a[172:175], v[200:203]
    v_cvt_pk_bf16_f32 v136, v212, v213
    v_cvt_pk_bf16_f32 v137, v214, v215
    v_mfma_f32_16x16x32_bf16 v[200:203], v[228:231], a[176:179], v[200:203]
    v_cvt_pk_bf16_f32 v144, v216, v217
    v_cvt_pk_bf16_f32 v145, v218, v219
    v_mfma_f32_16x16x32_bf16 v[204:207], v[220:223], a[192:195], 0
    ds_read_b128 v[220:223], v7 offset:48896
    v_mov_b32 v255, v254
    v_mfma_f32_16x16x32_bf16 v[204:207], v[224:227], a[196:199], v[204:207]
    ds_read_b128 v[224:227], v7 offset:49920
    v_permlane16_swap_b32 v254, v255
    v_mfma_f32_16x16x32_bf16 v[204:207], v[228:231], a[200:203], v[204:207]
    s_waitcnt lgkmcnt(3)
    ds_read_b128 v[228:231], v7 offset:50944
    buffer_load_dwordx4 v14, s[36:39], s18 offen offset:2048 lds
    v_mfma_f32_16x16x32_bf16 v[204:207], v[232:235], a[204:207], v[204:207]
    s_waitcnt lgkmcnt(3)
    v_max_f32 v254, v254, v255
    v_mov_b32 v255, v254
    v_mfma_f32_16x16x32_bf16 v[204:207], v[236:239], a[208:211], v[204:207]
    s_nop 0
    v_permlane32_swap_b32 v254, v255
    s_waitcnt lgkmcnt(2)
    v_mfma_f32_16x16x32_bf16 v[204:207], v[220:223], a[212:215], v[204:207]
    v_max_f32 v254, v254, v255
    v_mul_f32 v254, s54, v254
    v_mfma_f32_16x16x32_bf16 v[200:203], v[232:235], a[180:183], v[200:203]
    v_fma_f32 v180, v180, s54, -v254
    v_fma_f32 v181, v181, s54, -v254
    v_mfma_f32_16x16x32_bf16 v[200:203], v[236:239], a[184:187], v[200:203]
    v_fma_f32 v182, v182, s54, -v254
    v_fma_f32 v183, v183, s54, -v254
    v_mfma_f32_16x16x32_bf16 v[200:203], v[220:223], a[188:191], v[200:203]
    v_fma_f32 v184, v184, s54, -v254
    s_add_u32 m0, s56, 6144
    s_mov_b32 s18, 24576
    buffer_load_dwordx4 v12, s[36:39], s18 offen offset:0 lds
    v_mfma_f32_16x16x32_bf16 v[196:199], v[232:235], a[156:159], v[196:199]
    ds_read_b128 v[232:235], v7 offset:51968
    v_fma_f32 v185, v185, s54, -v254
    v_mfma_f32_16x16x32_bf16 v[196:199], v[236:239], a[160:163], v[196:199]
    ds_read_b128 v[236:239], v7 offset:52992
    v_fma_f32 v186, v186, s54, -v254
    v_mfma_f32_16x16x32_bf16 v[196:199], v[220:223], a[164:167], v[196:199]
    s_waitcnt lgkmcnt(3)
    ds_read_b128 v[220:223], v7 offset:54016
    v_fma_f32 v187, v187, s54, -v254
    v_mfma_f32_16x16x32_bf16 v[208:211], v[224:227], a[144:147], 0
    s_waitcnt lgkmcnt(3)
    v_fma_f32 v188, v188, s54, -v254
    v_fma_f32 v189, v189, s54, -v254
    v_mfma_f32_16x16x32_bf16 v[208:211], v[228:231], a[148:151], v[208:211]
    v_fma_f32 v190, v190, s54, -v254
    v_fma_f32 v191, v191, s54, -v254
    v_mfma_f32_16x16x32_bf16 v[212:215], v[224:227], a[168:171], 0
    s_waitcnt lgkmcnt(2)
    buffer_load_dwordx4 v13, s[36:39], s18 offen offset:1024 lds
    v_mfma_f32_16x16x32_bf16 v[208:211], v[232:235], a[152:155], v[208:211]
    v_fma_f32 v192, v192, s54, -v254
    v_exp_f32 v180, v180
    v_mfma_f32_16x16x32_bf16 v[212:215], v[228:231], a[172:175], v[212:215]
    v_exp_f32 v181, v181
    v_mfma_f32_16x16x32_bf16 v[212:215], v[232:235], a[176:179], v[212:215]
    v_exp_f32 v182, v182
    v_mfma_f32_16x16x32_bf16 v[216:219], v[224:227], a[192:195], 0
    ds_read_b128 v[224:227], v7 offset:55040
    v_cvt_pk_bf16_f32 v180, v180, v181
    v_mfma_f32_16x16x32_bf16 v[216:219], v[228:231], a[196:199], v[216:219]
    ds_read_b128 v[228:231], v7 offset:43776
    v_exp_f32 v183, v183
    v_mfma_f32_16x16x32_bf16 v[216:219], v[232:235], a[200:203], v[216:219]
    s_waitcnt lgkmcnt(3)
    ds_read_b128 v[232:235], v7 offset:44800
    buffer_load_dwordx4 v14, s[36:39], s18 offen offset:2048 lds
    v_mfma_f32_16x16x32_bf16 v[216:219], v[236:239], a[204:207], v[216:219]
    s_waitcnt lgkmcnt(3)
    v_exp_f32 v184, v184
    v_mfma_f32_16x16x32_bf16 v[216:219], v[220:223], a[208:211], v[216:219]
    s_waitcnt lgkmcnt(2)
    v_cvt_pk_bf16_f32 v181, v182, v183
    v_exp_f32 v185, v185
    v_mfma_f32_16x16x32_bf16 v[216:219], v[224:227], a[212:215], v[216:219]
    v_exp_f32 v186, v186
    v_mfma_f32_16x16x32_bf16 v[212:215], v[236:239], a[180:183], v[212:215]
    v_cvt_pk_bf16_f32 v182, v184, v185
    v_exp_f32 v187, v187
    v_mfma_f32_16x16x32_bf16 v[212:215], v[220:223], a[184:187], v[212:215]
    v_exp_f32 v188, v188
    v_mfma_f32_16x16x32_bf16 v[212:215], v[224:227], a[188:191], v[212:215]
    v_cvt_pk_bf16_f32 v183, v186, v187
    v_exp_f32 v189, v189
    v_mfma_f32_16x16x32_bf16 v[208:211], v[236:239], a[156:159], v[208:211]
    s_waitcnt vmcnt(9)
    s_barrier
    v_mfma_f32_16x16x32_bf16 v[208:211], v[220:223], a[160:163], v[208:211]
    ds_read_b128 v[236:239], v7 offset:45824
    ds_read_b128 v[220:223], v7 offset:46848
    v_mfma_f32_16x16x32_bf16 v[208:211], v[224:227], a[164:167], v[208:211]
    s_waitcnt lgkmcnt(3)
    ds_read_b128 v[224:227], v7 offset:47872
    v_exp_f32 v190, v190
    v_cvt_pk_bf16_f32 v184, v188, v189
    v_exp_f32 v191, v191
    v_exp_f32 v192, v192
    v_cvt_pk_bf16_f32 v185, v190, v191
    v_mov_b32 v187, 0
    v_cvt_pk_bf16_f32 v186, v192, 0
    v_cvt_pk_bf16_f32 v130, v196, v197
    v_cvt_pk_bf16_f32 v131, v198, v199
    v_mfma_f32_16x16x32_bf16 v[196:199], a[72:75], v[228:231], 0
    s_waitcnt lgkmcnt(3)
    ds_read_b128 v[172:175], v1 offset:0
    ds_read_b128 v[176:179], v1 offset:416
    v_mfma_f32_16x16x32_bf16 v[196:199], a[76:79], v[232:235], v[196:199]
    s_waitcnt lgkmcnt(4)
    ds_read_b128 v[188:191], v1 offset:832
    v_cvt_pk_bf16_f32 v138, v200, v201
    v_mfma_f32_16x16x32_bf16 v[196:199], a[80:83], v[236:239], v[196:199]
    ds_read_b128 v[192:195], v1 offset:4160
    v_cvt_pk_bf16_f32 v139, v202, v203
    v_mfma_f32_16x16x32_bf16 v[200:203], a[96:99], v[228:231], 0
    v_cvt_pk_bf16_f32 v146, v204, v205
    v_cvt_pk_bf16_f32 v147, v206, v207
    v_mfma_f32_16x16x32_bf16 v[200:203], a[100:103], v[232:235], v[200:203]
    v_cvt_pk_bf16_f32 v132, v208, v209
    v_cvt_pk_bf16_f32 v133, v210, v211
    v_mfma_f32_16x16x32_bf16 v[200:203], a[104:107], v[236:239], v[200:203]
    ds_read_b128 v[208:211], v17 offset:3072
    v_cvt_pk_bf16_f32 v140, v212, v213
    v_mfma_f32_16x16x32_bf16 v[204:207], a[120:123], v[228:231], 0
    ds_read_b128 v[228:231], v7 offset:48896
    v_cvt_pk_bf16_f32 v141, v214, v215
    v_mfma_f32_16x16x32_bf16 v[204:207], a[124:127], v[232:235], v[204:207]
    s_waitcnt vmcnt(6)
    ds_read_b64_tr_b16 a[216:217], v18 offset:0
    ds_read_b64_tr_b16 a[228:229], v18 offset:32
    v_mfma_f32_16x16x32_bf16 v[204:207], a[128:131], v[236:239], v[204:207]
    s_waitcnt lgkmcnt(9)
    ds_read_b64_tr_b16 a[240:241], v18 offset:64
    ds_read_b64_tr_b16 a[218:219], v18 offset:1536
    v_mfma_f32_16x16x32_bf16 v[204:207], a[132:135], v[220:223], v[204:207]
    s_waitcnt lgkmcnt(10)
    ds_read_b64_tr_b16 a[230:231], v18 offset:1568
    ds_read_b64_tr_b16 a[242:243], v18 offset:1600
    v_mfma_f32_16x16x32_bf16 v[204:207], a[136:139], v[224:227], v[204:207]
    ds_read_b128 v[212:215], v17 offset:4096
    ds_read_b128 v[236:239], v4 offset:7488
    v_mfma_f32_16x16x32_bf16 v[200:203], a[108:111], v[220:223], v[200:203]
    s_waitcnt lgkmcnt(8)
    ds_read_b128 v[232:235], v1 offset:4192
    v_cvt_pk_bf16_f32 v148, v216, v217
    v_mfma_f32_16x16x32_bf16 v[204:207], a[140:143], v[228:231], v[204:207]
    v_cvt_pk_bf16_f32 v149, v218, v219
    v_mfma_f32_16x16x32_bf16 v[200:203], a[112:115], v[224:227], v[200:203]
    ds_read_b128 v[216:219], v17 offset:5120
    v_mfma_f32_16x16x32_bf16 v[200:203], a[116:119], v[228:231], v[200:203]
    s_waitcnt lgkmcnt(4)
    s_add_u32 m0, s56, 0
    s_mov_b32 s18, 36864
    buffer_load_dwordx4 v12, s[36:39], s18 offen offset:0 lds
    v_mfma_f32_16x16x32_bf16 v[196:199], a[84:87], v[220:223], v[196:199]
    ds_read_b128 v[220:223], v1 offset:32
    v_cvt_pk_bf16_f32 v162, v204, v205
    v_mfma_f32_16x16x32_bf16 v[196:199], a[88:91], v[224:227], v[196:199]
    ds_read_b128 v[224:227], v1 offset:448
    v_cvt_pk_bf16_f32 v163, v206, v207
    v_mfma_f32_16x16x32_bf16 v[196:199], a[92:95], v[228:231], v[196:199]
    s_waitcnt lgkmcnt(4)
    ds_read_b128 v[204:207], v17 offset:2048
    ds_read_b128 v[228:231], v1 offset:864
    v_mfma_f32_16x16x32_bf16 v[68:71], v[20:23], v[236:239], 0
    s_waitcnt vmcnt(4)
    ds_read_b128 v[236:239], v4 offset:7520
    buffer_load_dwordx4 v13, s[36:39], s18 offen offset:1024 lds
    v_cvt_pk_bf16_f32 v160, v200, v201
    v_cvt_pk_bf16_f32 v161, v202, v203
    v_cvt_pk_bf16_f32 v158, v196, v197
    v_cvt_pk_bf16_f32 v159, v198, v199
    ds_read_b64_tr_b16 a[224:225], v18 offset:3072
    ds_read_b64_tr_b16 a[236:237], v18 offset:3104
    ds_read_b64_tr_b16 a[248:249], v18 offset:3136
    ds_read_b64_tr_b16 a[220:221], v18 offset:4608
    ds_read_b64_tr_b16 a[232:233], v18 offset:4640
    ds_read_b64_tr_b16 a[244:245], v18 offset:4672
    ds_read_b128 v[196:199], v17 offset:0
    ds_read_b128 v[200:203], v17 offset:1024
    buffer_load_dwordx4 v14, s[36:39], s18 offen offset:2048 lds
    s_waitcnt lgkmcnt(8)
    v_mfma_f32_16x16x32_bf16 v[72:75], v[24:27], v[236:239], 0
    ds_read_b128 v[236:239], v4 offset:7552
    s_nop 4
    v_smfmac_f32_16x16x64_bf16 v[72:75], v[204:207], v[220:227], v19
    ds_read_b128 v[220:223], v2 offset:0
    ds_read_b128 v[224:227], v2 offset:416
    v_smfmac_f32_16x16x64_bf16 v[72:75], v[208:211], v[228:235], v19
    s_waitcnt lgkmcnt(5)
    ds_read_b128 v[228:231], v2 offset:832
    s_add_u32 m0, s56, 3072
    s_mov_b32 s18, 49152
    buffer_load_dwordx4 v12, s[36:39], s18 offen offset:0 lds
    s_waitcnt lgkmcnt(5)
    v_smfmac_f32_16x16x64_bf16 v[68:71], v[196:199], v[172:179], v19
    s_waitcnt lgkmcnt(4)
    ds_read_b128 v[172:175], v1 offset:64
    ds_read_b128 v[176:179], v1 offset:480
    v_smfmac_f32_16x16x64_bf16 v[68:71], v[200:203], v[188:195], v19
    s_waitcnt lgkmcnt(5)
    ds_read_b128 v[188:191], v1 offset:896
    v_mfma_f32_16x16x32_bf16 v[76:79], v[28:31], v[236:239], 0
    ds_read_b128 v[192:195], v1 offset:4224
    ds_read_b128 v[236:239], v5 offset:7488
    buffer_load_dwordx4 v13, s[36:39], s18 offen offset:1024 lds
    ds_read_b128 v[232:235], v2 offset:4160
    s_nop 0
    v_add_f32 v240, v68, v69
    v_mul_f32 v241, v68, v68
    v_fmac_f32 v241, v69, v69
    v_add_f32 v240, v240, v70
    v_fmac_f32 v241, v70, v70
    v_add_f32 v240, v240, v71
    v_fmac_f32 v241, v71, v71
    v_add_f32 v240, v240, v72
    v_fmac_f32 v241, v72, v72
    s_waitcnt lgkmcnt(4)
    v_smfmac_f32_16x16x64_bf16 v[76:79], v[212:215], v[172:179], v19
    s_waitcnt lgkmcnt(2)
    ds_read_b128 v[172:175], v2 offset:32
    ds_read_b128 v[176:179], v2 offset:448
    buffer_load_dwordx4 v14, s[36:39], s18 offen offset:2048 lds
    v_smfmac_f32_16x16x64_bf16 v[76:79], v[216:219], v[188:195], v19
    s_waitcnt lgkmcnt(3)
    ds_read_b128 v[188:191], v2 offset:864
    ds_read_b128 v[192:195], v2 offset:4192
    v_mfma_f32_16x16x32_bf16 v[80:83], v[20:23], v[236:239], 0
    s_waitcnt vmcnt(6)
    ds_read_b128 v[236:239], v5 offset:7520
    ds_read_b64_tr_b16 a[222:223], v18 offset:6144
    ds_read_b64_tr_b16 a[234:235], v18 offset:6176
    ds_read_b64_tr_b16 a[246:247], v18 offset:6208
    ds_read_b64_tr_b16 a[226:227], v18 offset:7680
    v_smfmac_f32_16x16x64_bf16 v[80:83], v[196:199], v[220:227], v19
    s_waitcnt lgkmcnt(9)
    ds_read_b64_tr_b16 a[238:239], v18 offset:7712
    ds_read_b64_tr_b16 a[250:251], v18 offset:7744
    v_smfmac_f32_16x16x64_bf16 v[80:83], v[200:203], v[228:235], v19
    s_waitcnt lgkmcnt(6)
    ds_read_b128 v[220:223], v2 offset:64
    v_add_f32 v240, v240, v73
    v_fmac_f32 v241, v73, v73
    v_add_f32 v240, v240, v74
    v_fmac_f32 v241, v74, v74
    v_add_f32 v240, v240, v75
    v_fmac_f32 v241, v75, v75
    v_add_f32 v240, v240, v76
    v_fmac_f32 v241, v76, v76
    v_add_f32 v240, v240, v77
    v_mfma_f32_16x16x32_bf16 v[84:87], v[24:27], v[236:239], 0
    ds_read_b128 v[236:239], v5 offset:7552
    ds_read_b128 v[224:227], v2 offset:480
    v_fmac_f32 v241, v77, v77
    v_add_f32 v240, v240, v78
    v_fmac_f32 v241, v78, v78
    v_add_f32 v240, v240, v79
    v_smfmac_f32_16x16x64_bf16 v[84:87], v[204:207], v[172:179], v19
    ds_read_b128 v[228:231], v2 offset:896
    ds_read_b128 v[232:235], v2 offset:4224
    v_smfmac_f32_16x16x64_bf16 v[84:87], v[208:211], v[188:195], v19
    s_waitcnt lgkmcnt(5)
    s_add_u32 m0, s56, 6144
    s_mov_b32 s18, 61440
    buffer_load_dwordx4 v12, s[36:39], s18 offen offset:0 lds
    ds_read_b128 v[172:175], v3 offset:0
    ds_read_b128 v[176:179], v3 offset:416
    v_fmac_f32 v241, v79, v79
    v_add_f32 v242, v80, v81
    v_mul_f32 v243, v80, v80
    v_permlane16_swap_b32 v240, v241
    s_waitcnt lgkmcnt(5)
    v_mfma_f32_16x16x32_bf16 v[88:91], v[28:31], v[236:239], 0
    s_waitcnt lgkmcnt(4)
    ds_read_b128 v[236:239], v6 offset:7488
    ds_read_b128 v[188:191], v3 offset:832
    v_add_f32 v240, v240, v241
    v_fmac_f32 v243, v81, v81
    buffer_load_dwordx4 v13, s[36:39], s18 offen offset:1024 lds
    ds_read_b128 v[192:195], v3 offset:4160
    v_smfmac_f32_16x16x64_bf16 v[88:91], v[212:215], v[220:227], v19
    s_waitcnt lgkmcnt(5)
    ds_read_b128 v[220:223], v3 offset:32
    ds_read_b128 v[224:227], v3 offset:448
    v_smfmac_f32_16x16x64_bf16 v[88:91], v[216:219], v[228:235], v19
    s_waitcnt lgkmcnt(4)
    ds_read_b128 v[228:231], v3 offset:864
    v_add_f32 v242, v242, v82
    v_fmac_f32 v243, v82, v82
    v_add_f32 v242, v242, v83
    v_fmac_f32 v243, v83, v83
    v_add_f32 v242, v242, v84
    v_fmac_f32 v243, v84, v84
    v_mfma_f32_16x16x32_bf16 v[92:95], v[20:23], v[236:239], 0
    ds_read_b128 v[236:239], v6 offset:7520
    ds_read_b128 v[232:235], v3 offset:4192
    buffer_load_dwordx4 v14, s[36:39], s18 offen offset:2048 lds
    v_add_f32 v242, v242, v85
    v_fmac_f32 v243, v85, v85
    v_add_f32 v242, v242, v86
    v_smfmac_f32_16x16x64_bf16 v[92:95], v[196:199], v[172:179], v19
    s_waitcnt lgkmcnt(5)
    ds_read_b128 v[172:175], v3 offset:64
    ds_read_b128 v[176:179], v3 offset:480
    v_smfmac_f32_16x16x64_bf16 v[92:95], v[200:203], v[188:195], v19
    ds_read_b128 v[188:191], v3 offset:896
    v_fmac_f32 v243, v86, v86
    v_mfma_f32_16x16x32_bf16 v[196:199], v[128:131], v[180:183], 0
    ds_read_b128 v[192:195], v3 offset:4224
    v_add_f32 v242, v242, v87
    v_mfma_f32_16x16x32_bf16 v[196:199], v[132:135], v[184:187], v[196:199]
    s_waitcnt lgkmcnt(5)
    v_fmac_f32 v243, v87, v87
    v_add_f32 v242, v242, v88
    v_mfma_f32_16x16x32_bf16 v[96:99], v[24:27], v[236:239], 0
    ds_read_b128 v[236:239], v6 offset:7552
    v_fmac_f32 v243, v88, v88
    v_mfma_f32_16x16x32_bf16 v[200:203], v[136:139], v[180:183], 0
    v_add_f32 v242, v242, v89
    v_fmac_f32 v243, v89, v89
    v_mfma_f32_16x16x32_bf16 v[200:203], v[140:143], v[184:187], v[200:203]
    v_add_f32 v242, v242, v90
    v_fmac_f32 v243, v90, v90
    v_smfmac_f32_16x16x64_bf16 v[96:99], v[204:207], v[220:227], v19
    s_waitcnt lgkmcnt(5)
    ds_read_b128 v[220:223], v7 offset:51968
    ds_read_b128 v[224:227], v7 offset:52992
    v_smfmac_f32_16x16x64_bf16 v[96:99], v[208:211], v[228:235], v19
    ds_read_b128 v[232:235], v7 offset:49920
    v_add_f32 v242, v242, v91
    v_mfma_f32_16x16x32_bf16 v[208:211], v[128:131], v[164:167], 0
    s_waitcnt lgkmcnt(3)
    ds_read_b128 v[228:231], v7 offset:54016
    v_fmac_f32 v243, v91, v91
    v_mfma_f32_16x16x32_bf16 v[100:103], v[28:31], v[236:239], 0
    ds_read_b128 v[236:239], v7 offset:50944
    v_permlane16_swap_b32 v242, v243
    v_mfma_f32_16x16x32_bf16 v[208:211], v[132:135], v[168:171], v[208:211]
    v_add_f32 v242, v242, v243
    v_add_f32 v244, v92, v93
    v_mfma_f32_16x16x32_bf16 v[204:207], v[144:147], v[180:183], 0
    v_permlane32_swap_b32 v240, v242
    v_smfmac_f32_16x16x64_bf16 v[100:103], v[212:215], v[172:179], v19
    v_add_f32 v240, v240, v242
    v_mul_f32 v245, v92, v92
    v_smfmac_f32_16x16x64_bf16 v[100:103], v[216:219], v[188:195], v19
    ds_write_b32 v10, v240 offset:0
    v_mfma_f32_16x16x32_bf16 v[172:175], a[252:255], v[164:167], 0
    v_fmac_f32 v245, v93, v93
    v_add_f32 v244, v244, v94
    v_mfma_f32_16x16x32_bf16 v[172:175], a[252:255], v[168:171], v[172:175]
    v_fmac_f32 v245, v94, v94
    v_add_f32 v244, v244, v95
    v_mfma_f32_16x16x32_bf16 v[212:215], v[136:139], v[164:167], 0
    v_fmac_f32 v245, v95, v95
    v_add_f32 v244, v244, v96
    v_mfma_f32_16x16x32_bf16 v[212:215], v[140:143], v[168:171], v[212:215]
    v_fmac_f32 v245, v96, v96
    v_add_f32 v244, v244, v97
    v_mfma_f32_16x16x32_bf16 v[216:219], v[144:147], v[164:167], 0
    v_fmac_f32 v245, v97, v97
    v_add_f32 v244, v244, v98
    v_mfma_f32_16x16x32_bf16 v[216:219], v[148:151], v[168:171], v[216:219]
    v_fmac_f32 v245, v98, v98
    v_add_f32 v244, v244, v99
    v_mfma_f32_16x16x32_bf16 v[164:167], v[104:107], v[158:161], 0
    v_fmac_f32 v245, v99, v99
    v_add_f32 v244, v244, v100
    v_mfma_f32_16x16x32_bf16 v[168:171], v[110:113], v[158:161], 0
    v_fmac_f32 v245, v100, v100
    v_add_f32 v244, v244, v101
    v_mfma_f32_16x16x32_bf16 v[176:179], v[122:125], v[158:161], v[0:3]
    v_fmac_f32 v245, v101, v101
    v_add_f32 v244, v244, v102
    v_mfma_f32_16x16x16_bf16 v[164:167], v[108:109], v[162:163], v[164:167]
    v_fmac_f32 v245, v102, v102
    v_add_f32 v244, v244, v103
    v_mfma_f32_16x16x16_bf16 v[168:171], v[114:115], v[162:163], v[168:171]
    v_fmac_f32 v245, v103, v103
    v_rcp_f32 v172, v172
    v_mfma_f32_16x16x16_bf16 v[176:179], v[126:127], v[162:163], v[176:179]
    v_permlane16_swap_b32 v244, v245
    v_mfma_f32_16x16x32_bf16 v[188:191], a[252:255], v[180:183], 0
    v_add_f32 v244, v244, v245
    v_mov_b32 v246, v244
    v_mfma_f32_16x16x32_bf16 v[188:191], a[252:255], v[184:187], v[188:191]
    s_nop 0
    v_permlane32_swap_b32 v244, v246
    v_mfma_f32_16x16x32_bf16 v[204:207], v[148:151], v[184:187], v[204:207]
    v_add_f32 v244, v244, v246
    ds_write_b32 v10, v244 offset:1024
    v_mul_f32 v208, v172, v208
    v_mul_f32 v209, v172, v209
    v_cvt_pk_bf16_f32 v208, v208, v209
    v_mul_f32 v210, v172, v210
    v_mul_f32 v211, v172, v211
    v_cvt_pk_bf16_f32 v209, v210, v211
    v_mul_f32 v212, v172, v212
    v_mul_f32 v213, v172, v213
    v_cvt_pk_bf16_f32 v210, v212, v213
    v_mul_f32 v214, v172, v214
    v_mul_f32 v215, v172, v215
    v_cvt_pk_bf16_f32 v211, v214, v215
    v_mul_f32 v216, v172, v216
    v_mul_f32 v217, v172, v217
    v_cvt_pk_bf16_f32 v212, v216, v217
    v_mul_f32 v218, v172, v218
    v_mul_f32 v219, v172, v219
    v_mfma_f32_16x16x32_bf16 v[172:175], v[116:119], v[158:161], 0
    s_waitcnt lgkmcnt(0)
    s_barrier
    s_add_u32 m0, s79, 0
    s_add_u32 s18, s90, 0
    buffer_load_dwordx4 v16, s[24:27], s18 offen nt lds
    s_mov_b64 exec, s[80:81]
    ds_write_b128 v8, v[208:211] offset:56832
    s_mov_b64 exec, -1
    v_mfma_f32_16x16x32_bf16 v[208:211], a[72:75], v[232:235], 0
    ds_read_b128 v[240:243], v248 offset:0
    ds_read_b128 v[244:247], v248 offset:16
    v_mfma_f32_16x16x16_bf16 v[172:175], v[120:121], v[162:163], v[172:175]
    v_cvt_pk_bf16_f32 v213, v218, v219
    v_rcp_f32 v188, v188
    v_mfma_f32_16x16x32_bf16 v[208:211], a[76:79], v[236:239], v[208:211]
    v_mul_f32 v196, v188, v196
    v_mul_f32 v197, v188, v197
    v_mfma_f32_16x16x32_bf16 v[208:211], a[80:83], v[220:223], v[208:211]
    s_mov_b64 exec, s[80:81]
    ds_write_b64 v9, v[212:213] offset:56832
    s_mov_b64 exec, -1
    v_mfma_f32_16x16x32_bf16 v[212:215], a[96:99], v[232:235], 0
    s_add_u32 m0, s79, 3744
    s_add_u32 s18, s90, 86016
    buffer_load_dwordx4 v16, s[20:23], s18 offen nt lds
    v_mfma_f32_16x16x32_bf16 v[212:215], a[100:103], v[236:239], v[212:215]
    s_mov_b32 s80, 0x100010
    v_cvt_pk_bf16_f32 v196, v196, v197
    v_mul_f32 v198, v188, v198
    v_mfma_f32_16x16x32_bf16 v[212:215], a[104:107], v[220:223], v[212:215]
    s_mov_b32 s81, 0x100010
    v_mul_f32 v199, v188, v199
    v_cvt_pk_bf16_f32 v197, v198, v199
    v_mfma_f32_16x16x32_bf16 v[216:219], a[120:123], v[232:235], 0
    ds_read_b128 v[232:235], v7 offset:55040
    v_mul_f32 v200, v188, v200
    v_mfma_f32_16x16x32_bf16 v[216:219], a[124:127], v[236:239], v[216:219]
    v_mul_f32 v201, v188, v201
    v_cvt_pk_bf16_f32 v198, v200, v201
    v_mfma_f32_16x16x32_bf16 v[216:219], a[128:131], v[220:223], v[216:219]
    v_mul_f32 v202, v188, v202
    v_mul_f32 v203, v188, v203
    v_mfma_f32_16x16x32_bf16 v[216:219], a[132:135], v[224:227], v[216:219]
    v_cvt_pk_bf16_f32 v199, v202, v203
    v_mul_f32 v204, v188, v204
    v_mfma_f32_16x16x32_bf16 v[216:219], a[136:139], v[228:231], v[216:219]
    s_waitcnt lgkmcnt(0)
    ds_write_b128 v8, v[196:199] offset:19200
    v_mfma_f32_16x16x32_bf16 v[216:219], a[140:143], v[232:235], v[216:219]
    s_add_u32 m0, s79, 7488
    s_add_u32 s18, s90, 172032
    buffer_load_dwordx4 v16, s[20:23], s18 offen nt lds
    v_mfma_f32_16x16x32_bf16 v[212:215], a[108:111], v[224:227], v[212:215]
    v_mul_f32 v205, v188, v205
    v_cvt_pk_bf16_f32 v200, v204, v205
    v_mfma_f32_16x16x32_bf16 v[212:215], a[112:115], v[228:231], v[212:215]
    v_mul_f32 v206, v188, v206
    v_mul_f32 v207, v188, v207
    v_mfma_f32_16x16x32_bf16 v[212:215], a[116:119], v[232:235], v[212:215]
    v_cvt_pk_bf16_f32 v201, v206, v207
    v_add_f32 v240, v240, v241
    v_mfma_f32_16x16x32_bf16 v[208:211], a[84:87], v[224:227], v[208:211]
    ds_write_b64 v9, v[200:201] offset:19200
    v_mfma_f32_16x16x32_bf16 v[208:211], a[88:91], v[228:231], v[208:211]
    v_add_f32 v242, v242, v243
    v_add_f32 v244, v244, v245
    v_mfma_f32_16x16x32_bf16 v[208:211], a[92:95], v[232:235], v[208:211]
    v_add_f32 v246, v246, v247
    v_add_f32 v240, v240, v242
    s_add_u32 m0, s79, 11232
    s_add_u32 s18, s90, 258048
    buffer_load_dwordx4 v16, s[20:23], s18 offen nt lds
    v_add_f32 v244, v244, v246
    v_mul_f32 v240, s59, v240
    v_fma_f32 v241, v240, v240, -s60
    v_fma_f32 v244, v244, s59, -v241
    v_max_f32 v244, s60, v244
    v_rsq_f32 v248, v244
    ds_bpermute_b32 v250, v11, v248 offset:0
    ds_bpermute_b32 v254, v11, v248 offset:64
    v_mul_f32 v249, v240, v248
    ds_bpermute_b32 v251, v11, v249 offset:0
    ds_bpermute_b32 v255, v11, v249 offset:64
    v_cvt_pk_bf16_f32 v158, v208, v209
    v_cvt_pk_bf16_f32 v159, v210, v211
    v_cvt_pk_bf16_f32 v160, v212, v213
    v_cvt_pk_bf16_f32 v161, v214, v215
    v_cvt_pk_bf16_f32 v162, v216, v217
    v_cvt_pk_bf16_f32 v163, v218, v219
    v_mfma_f32_16x16x32_bf16 v[180:183], v[104:107], v[158:161], 0
    s_add_u32 m0, s79, 14976
    s_add_u32 s18, s90, 344064
    buffer_load_dwordx4 v16, s[20:23], s18 offen nt lds
    v_mfma_f32_16x16x32_bf16 v[184:187], v[110:113], v[158:161], 0
    v_max3_f32 v252, v164, v165, v166
    v_max3_f32 v253, v167, v168, v169
    v_mfma_f32_16x16x32_bf16 v[188:191], v[116:119], v[158:161], 0
    s_waitcnt lgkmcnt(1)
    v_fma_f32 v246, v68, v250, -v251
    v_fma_f32 v247, v69, v250, -v251
    v_mfma_f32_16x16x32_bf16 v[192:195], v[122:125], v[158:161], v[0:3]
    s_waitcnt vmcnt(5)
    ds_read_b64_tr_b16 v[158:159], v18 offset:4608
    ds_read_b64_tr_b16 v[160:161], v18 offset:6144
    v_mfma_f32_16x16x16_bf16 v[180:183], v[108:109], v[162:163], v[180:183]
    v_cvt_pk_bf16_f32 v240, v246, v247
    v_fma_f32 v246, v70, v250, -v251
    v_mfma_f32_16x16x16_bf16 v[184:187], v[114:115], v[162:163], v[184:187]
    v_fma_f32 v247, v71, v250, -v251
    v_cvt_pk_bf16_f32 v241, v246, v247
    v_mfma_f32_16x16x16_bf16 v[188:191], v[120:121], v[162:163], v[188:191]
    v_fma_f32 v246, v72, v250, -v251
    v_fma_f32 v247, v73, v250, -v251
    v_mfma_f32_16x16x16_bf16 v[192:195], v[126:127], v[162:163], v[192:195]
    s_waitcnt lgkmcnt(2)
    s_add_u32 m0, s79, 18720
    s_add_u32 s18, s90, 430080
    buffer_load_dwordx4 v16, s[20:23], s18 offen nt lds
    v_cvt_pk_bf16_f32 v242, v246, v247
    v_fma_f32 v246, v74, v250, -v251
    v_fma_f32 v247, v75, v250, -v251
    v_cvt_pk_bf16_f32 v243, v246, v247
    v_fma_f32 v246, v76, v250, -v251
    v_fma_f32 v247, v77, v250, -v251
    v_cvt_pk_bf16_f32 v244, v246, v247
    v_fma_f32 v246, v78, v250, -v251
    v_fma_f32 v247, v79, v250, -v251
    v_cvt_pk_bf16_f32 v245, v246, v247
    ds_write_b128 v8, v[240:243] offset:0
    v_fma_f32 v246, v80, v254, -v255
    v_fma_f32 v247, v81, v254, -v255
    v_cvt_pk_bf16_f32 v240, v246, v247
    v_fma_f32 v246, v82, v254, -v255
    v_fma_f32 v247, v83, v254, -v255
    v_cvt_pk_bf16_f32 v241, v246, v247
    v_fma_f32 v246, v84, v254, -v255
    s_add_u32 m0, s79, 22464
    s_add_u32 s18, s90, 516096
    buffer_load_dwordx4 v16, s[20:23], s18 offen nt lds
    ds_bpermute_b32 v250, v11, v248 offset:128
    ds_bpermute_b32 v251, v11, v249 offset:128
    ds_write_b64 v9, v[244:245] offset:0
    v_fma_f32 v247, v85, v254, -v255
    v_cvt_pk_bf16_f32 v242, v246, v247
    v_fma_f32 v246, v86, v254, -v255
    v_fma_f32 v247, v87, v254, -v255
    v_cvt_pk_bf16_f32 v243, v246, v247
    v_fma_f32 v246, v88, v254, -v255
    v_fma_f32 v247, v89, v254, -v255
    v_cvt_pk_bf16_f32 v244, v246, v247
    v_fma_f32 v246, v90, v254, -v255
    v_fma_f32 v247, v91, v254, -v255
    v_cvt_pk_bf16_f32 v245, v246, v247
    v_max3_f32 v252, v252, v170, v171
    v_max3_f32 v253, v253, v172, v173
    v_max3_f32 v252, v252, v174, v175
    s_waitcnt lgkmcnt(1)
    v_fma_f32 v246, v92, v250, -v251
    v_fma_f32 v247, v93, v250, -v251
    v_max3_f32 v252, v252, v253, v176
    s_add_u32 m0, s79, 26208
    s_add_u32 s18, s90, 602112
    buffer_load_dwordx4 v16, s[20:23], s18 offen nt lds
    ds_write_b128 v8, v[240:243] offset:6144
    v_mov_b32 v253, v252
    v_max3_f32 v254, v180, v181, v182
    v_cvt_pk_bf16_f32 v240, v246, v247
    v_fma_f32 v246, v94, v250, -v251
    v_fma_f32 v247, v95, v250, -v251
    v_cvt_pk_bf16_f32 v241, v246, v247
    v_fma_f32 v246, v96, v250, -v251
    v_fma_f32 v247, v97, v250, -v251
    v_cvt_pk_bf16_f32 v242, v246, v247
    v_fma_f32 v246, v98, v250, -v251
    v_fma_f32 v247, v99, v250, -v251
    v_cvt_pk_bf16_f32 v243, v246, v247
    v_fma_f32 v246, v100, v250, -v251
    v_fma_f32 v247, v101, v250, -v251
    v_permlane16_swap_b32 v252, v253
    ds_write_b64 v9, v[244:245] offset:6144
    s_add_u32 m0, s79, 29952
    s_add_u32 s18, s90, 688128
    buffer_load_dwordx4 v16, s[28:31], s18 offen nt lds
    v_max_f32 v252, v252, v253
    v_cvt_pk_bf16_f32 v244, v246, v247
    v_fma_f32 v246, v102, v250, -v251
    v_fma_f32 v247, v103, v250, -v251
    v_cvt_pk_bf16_f32 v245, v246, v247
    v_mov_b32 v253, v252
    v_max3_f32 v255, v183, v184, v185
    v_max3_f32 v254, v254, v186, v187
    v_permlane32_swap_b32 v252, v253
    v_max_f32 v252, v252, v253
    v_mul_f32 v252, s54, v252
    v_fma_f32 v164, v164, s54, -v252
    v_fma_f32 v165, v165, s54, -v252
    ds_write_b128 v8, v[240:243] offset:12288
    v_fma_f32 v166, v166, s54, -v252
    v_fma_f32 v167, v167, s54, -v252
    v_subrev_u32 v240, 95232, v7
    v_bfe_u32 v241, v240, 4, 4
    v_mul_u32_u24 v241, 400, v241
    v_bfe_u32 v242, v240, 8, 2
    v_lshl_add_u32 v241, v242, 3, v241
    v_add_u32 v241, 95232, v241
    v_add_u32 v12, s61, v241
    v_lshrrev_b32 v241, 7, v240
    v_and_b32 v242, 127, v240
    v_mul_u32_u24 v243, 2800, v241
    v_add3_u32 v13, v243, v242, s73
    v_cmp_le_u32 vcc, s74, v241
    v_subrev_u32 v243, 9600, v13
    ds_write_b64 v9, v[244:245] offset:12288
    v_cndmask_b32 v13, v13, v243, vcc
    v_sub_u32 v243, 6, v241
    v_mul_u32_u24 v243, 86016, v243
    v_add3_u32 v243, v243, v242, s75
    v_mov_b32 v242, 0x80000000
    v_cmp_ne_u32 vcc, 7, v241
    v_fma_f32 v168, v168, s54, -v252
    v_fma_f32 v169, v169, s54, -v252
    v_cndmask_b32 v14, v242, v243, vcc
    v_cmp_ne_u32 vcc, s76, v241
    v_fma_f32 v170, v170, s54, -v252
    v_fma_f32 v171, v171, s54, -v252
    v_cndmask_b32 v15, v242, v14, vcc
    v_or_b32 v15, s77, v15
    v_fma_f32 v172, v172, s54, -v252
    v_fma_f32 v173, v173, s54, -v252
    v_fma_f32 v174, v174, s54, -v252
    v_fma_f32 v175, v175, s54, -v252
    v_fma_f32 v176, v176, s54, -v252
    v_exp_f32 v164, v164
    s_waitcnt lgkmcnt(0)
    s_barrier
    ds_read_b128 v[236:239], v7 offset:0
    ds_read_b128 v[220:223], v7 offset:1024
    ds_read_b128 v[224:227], v7 offset:2048
    v_exp_f32 v165, v165
    ds_read_b128 v[228:231], v7 offset:3072
    ds_read_b128 v[232:235], v7 offset:4096
    v_exp_f32 v166, v166
    v_cvt_pk_bf16_f32 v164, v164, v165
    v_exp_f32 v167, v167
    v_exp_f32 v168, v168
    v_cvt_pk_bf16_f32 v165, v166, v167
    v_exp_f32 v169, v169
    s_waitcnt lgkmcnt(4)
    v_mfma_f32_16x16x32_bf16 v[208:211], a[0:3], v[236:239], 0
    s_mov_b64 vcc, 0
    v_exp_f32 v170, v170
    s_waitcnt lgkmcnt(3)
    v_mfma_f32_16x16x32_bf16 v[208:211], a[4:7], v[220:223], v[208:211]
    s_mov_b32 vcc_lo, 0xffff0000
    v_cvt_pk_bf16_f32 v166, v168, v169
    v_exp_f32 v171, v171
    s_waitcnt lgkmcnt(2)
    v_mfma_f32_16x16x32_bf16 v[208:211], a[8:11], v[224:227], v[208:211]
    v_exp_f32 v172, v172
    v_mfma_f32_16x16x32_bf16 v[212:215], a[24:27], v[236:239], 0
    v_cvt_pk_bf16_f32 v167, v170, v171
    v_exp_f32 v173, v173
    v_mfma_f32_16x16x32_bf16 v[212:215], a[28:31], v[220:223], v[212:215]
    v_exp_f32 v174, v174
    v_mfma_f32_16x16x32_bf16 v[196:199], v[128:131], v[164:167], 0
    v_cvt_pk_bf16_f32 v168, v172, v173
    v_exp_f32 v175, v175
    v_mfma_f32_16x16x32_bf16 v[200:203], v[136:139], v[164:167], 0
    v_exp_f32 v176, v176
    v_mfma_f32_16x16x32_bf16 v[204:207], v[144:147], v[164:167], 0
    v_cvt_pk_bf16_f32 v169, v174, v175
    v_mov_b32 v171, 0
    v_mfma_f32_16x16x32_bf16 v[172:175], a[252:255], v[164:167], 0
    v_cvt_pk_bf16_f32 v170, v176, 0
    v_max3_f32 v255, v255, v188, v189
    v_mfma_f32_16x16x32_bf16 v[212:215], a[32:35], v[224:227], v[212:215]
    v_max3_f32 v254, v254, v190, v191
    v_max3_f32 v254, v254, v255, v192
    v_mfma_f32_16x16x32_bf16 v[172:175], a[252:255], v[168:171], v[172:175]
    v_mov_b32 v255, v254
    v_mov_b32 v0, 0xff800000
    v_mfma_f32_16x16x32_bf16 v[196:199], v[132:135], v[168:171], v[196:199]
    v_permlane16_swap_b32 v254, v255
    v_mfma_f32_16x16x32_bf16 v[200:203], v[140:143], v[168:171], v[200:203]
    v_max_f32 v254, v254, v255
    v_mov_b32 v255, v254
    v_mfma_f32_16x16x32_bf16 v[204:207], v[148:151], v[168:171], v[204:207]
    v_rcp_f32 v172, v172
    v_mfma_f32_16x16x32_bf16 v[216:219], a[48:51], v[236:239], 0
    ds_read_b128 v[236:239], v7 offset:5120
    v_mul_f32 v196, v172, v196
    v_mfma_f32_16x16x32_bf16 v[216:219], a[52:55], v[220:223], v[216:219]
    ds_read_b128 v[220:223], v7 offset:6144
    v_mul_f32 v197, v172, v197
    v_mfma_f32_16x16x32_bf16 v[216:219], a[56:59], v[224:227], v[216:219]
    s_waitcnt lgkmcnt(3)
    ds_read_b128 v[224:227], v7 offset:7168
    v_cvt_pk_bf16_f32 v196, v196, v197
    v_mfma_f32_16x16x32_bf16 v[216:219], a[60:63], v[228:231], v[216:219]
    s_waitcnt lgkmcnt(3)
    v_mul_f32 v198, v172, v198
    v_mul_f32 v199, v172, v199
    v_mfma_f32_16x16x32_bf16 v[216:219], a[64:67], v[232:235], v[216:219]
    v_cvt_pk_bf16_f32 v197, v198, v199
    v_mul_f32 v200, v172, v200
    v_mfma_f32_16x16x32_bf16 v[212:215], a[36:39], v[228:231], v[212:215]
    s_waitcnt lgkmcnt(2)
    v_mul_f32 v201, v172, v201
    v_cvt_pk_bf16_f32 v198, v200, v201
    v_mfma_f32_16x16x32_bf16 v[216:219], a[68:71], v[236:239], v[216:219]
    v_mul_f32 v202, v172, v202
    v_mul_f32 v203, v172, v203
    v_mfma_f32_16x16x32_bf16 v[212:215], a[40:43], v[232:235], v[212:215]
    v_cvt_pk_bf16_f32 v199, v202, v203
    v_mul_f32 v204, v172, v204
    v_mfma_f32_16x16x32_bf16 v[212:215], a[44:47], v[236:239], v[212:215]
    ds_write_b128 v8, v[196:199] offset:25344
    v_mfma_f32_16x16x32_bf16 v[208:211], a[12:15], v[228:231], v[208:211]
    ds_read_b128 v[228:231], v7 offset:8192
    v_mul_f32 v205, v172, v205
    v_mfma_f32_16x16x32_bf16 v[208:211], a[16:19], v[232:235], v[208:211]
    ds_read_b128 v[232:235], v7 offset:9216
    v_cvt_pk_bf16_f32 v200, v204, v205
    v_mfma_f32_16x16x32_bf16 v[208:211], a[20:23], v[236:239], v[208:211]
    s_waitcnt lgkmcnt(4)
    ds_read_b128 v[236:239], v7 offset:10240
    v_mul_f32 v206, v172, v206
    v_mfma_f32_16x16x32_bf16 v[196:199], a[0:3], v[220:223], 0
    s_waitcnt lgkmcnt(4)
    v_mul_f32 v207, v172, v207
    v_cvt_pk_bf16_f32 v201, v206, v207
    v_mfma_f32_16x16x32_bf16 v[196:199], a[4:7], v[224:227], v[196:199]
    ds_write_b64 v9, v[200:201] offset:25344
    v_mfma_f32_16x16x32_bf16 v[200:203], a[24:27], v[220:223], 0
    v_cvt_pk_bf16_f32 v104, v208, v209
    v_cvt_pk_bf16_f32 v105, v210, v211
    v_mfma_f32_16x16x32_bf16 v[200:203], a[28:31], v[224:227], v[200:203]
    s_waitcnt lgkmcnt(3)
    v_cvt_pk_bf16_f32 v106, v212, v213
    v_cvt_pk_bf16_f32 v107, v214, v215
    v_mfma_f32_16x16x32_bf16 v[196:199], a[8:11], v[228:231], v[196:199]
    v_cvt_pk_bf16_f32 v108, v216, v217
    v_cvt_pk_bf16_f32 v109, v218, v219
    v_mfma_f32_16x16x32_bf16 v[200:203], a[32:35], v[228:231], v[200:203]
    v_permlane32_swap_b32 v254, v255
    v_mfma_f32_16x16x32_bf16 v[204:207], a[48:51], v[220:223], 0
    ds_read_b128 v[220:223], v7 offset:11264
    v_max_f32 v254, v254, v255
    v_mfma_f32_16x16x32_bf16 v[204:207], a[52:55], v[224:227], v[204:207]
    ds_read_b128 v[224:227], v7 offset:12288
    v_mul_f32 v254, s54, v254
    v_mfma_f32_16x16x32_bf16 v[204:207], a[56:59], v[228:231], v[204:207]
    s_waitcnt lgkmcnt(4)
    ds_read_b128 v[228:231], v7 offset:13312
    v_fma_f32 v180, v180, s54, -v254
    v_mfma_f32_16x16x32_bf16 v[204:207], a[60:63], v[232:235], v[204:207]
    s_waitcnt lgkmcnt(4)
    v_fma_f32 v181, v181, s54, -v254
    v_fma_f32 v182, v182, s54, -v254
    v_mfma_f32_16x16x32_bf16 v[204:207], a[64:67], v[236:239], v[204:207]
    v_fma_f32 v183, v183, s54, -v254
    v_fma_f32 v184, v184, s54, -v254
    v_mfma_f32_16x16x32_bf16 v[200:203], a[36:39], v[232:235], v[200:203]
    s_waitcnt lgkmcnt(2)
    v_fma_f32 v185, v185, s54, -v254
    v_fma_f32 v186, v186, s54, -v254
    v_mfma_f32_16x16x32_bf16 v[204:207], a[68:71], v[220:223], v[204:207]
    v_fma_f32 v187, v187, s54, -v254
    v_fma_f32 v188, v188, s54, -v254
    v_mfma_f32_16x16x32_bf16 v[200:203], a[40:43], v[236:239], v[200:203]
    v_fma_f32 v189, v189, s54, -v254
    v_fma_f32 v190, v190, s54, -v254
    v_mfma_f32_16x16x32_bf16 v[200:203], a[44:47], v[220:223], v[200:203]
    v_fma_f32 v191, v191, s54, -v254
    v_fma_f32 v192, v192, s54, -v254
    v_mfma_f32_16x16x32_bf16 v[196:199], a[12:15], v[232:235], v[196:199]
    ds_read_b128 v[232:235], v7 offset:14336
    v_exp_f32 v180, v180
    v_mfma_f32_16x16x32_bf16 v[196:199], a[16:19], v[236:239], v[196:199]
    ds_read_b128 v[236:239], v7 offset:15360
    v_exp_f32 v181, v181
    v_mfma_f32_16x16x32_bf16 v[196:199], a[20:23], v[220:223], v[196:199]
    ds_read_b128 v[220:223], v7 offset:16384
    v_exp_f32 v182, v182
    v_mfma_f32_16x16x32_bf16 v[164:167], v[104:107], v[152:155], 0
    v_cvt_pk_bf16_f32 v180, v180, v181
    v_exp_f32 v183, v183
    v_exp_f32 v184, v184
    v_cvt_pk_bf16_f32 v181, v182, v183
    v_exp_f32 v185, v185
    v_exp_f32 v186, v186
    v_mfma_f32_16x16x16_bf16 v[164:167], v[108:109], v[156:157], v[164:167]
    v_cvt_pk_bf16_f32 v182, v184, v185
    v_exp_f32 v187, v187
    v_exp_f32 v188, v188
    v_cvt_pk_bf16_f32 v183, v186, v187
    v_exp_f32 v189, v189
    v_exp_f32 v190, v190
    v_mfma_f32_16x16x32_bf16 v[208:211], v[128:131], v[180:183], 0
    ds_read_b64_tr_b16 v[128:129], v18 offset:0
    ds_read_b64_tr_b16 v[130:131], v18 offset:1536
    v_mfma_f32_16x16x32_bf16 v[212:215], v[136:139], v[180:183], 0
    ds_read_b64_tr_b16 v[136:137], v18 offset:32
    ds_read_b64_tr_b16 v[138:139], v18 offset:1568
    v_mfma_f32_16x16x32_bf16 v[216:219], v[144:147], v[180:183], 0
    ds_read_b64_tr_b16 v[144:145], v18 offset:64
    ds_read_b64_tr_b16 v[146:147], v18 offset:1600
    v_cvt_pk_bf16_f32 v184, v188, v189
    v_exp_f32 v191, v191
    v_exp_f32 v192, v192
    v_cvt_pk_bf16_f32 v185, v190, v191
    v_mfma_f32_16x16x32_bf16 v[188:191], a[252:255], v[180:183], 0
    v_mov_b32 v187, 0
    v_cvt_pk_bf16_f32 v186, v192, 0
    v_cvt_pk_bf16_f32 v110, v196, v197
    v_cvt_pk_bf16_f32 v111, v198, v199
    v_mfma_f32_16x16x32_bf16 v[188:191], a[252:255], v[184:187], v[188:191]
    v_cvt_pk_bf16_f32 v112, v200, v201
    v_cvt_pk_bf16_f32 v113, v202, v203
    v_mfma_f32_16x16x32_bf16 v[208:211], v[132:135], v[184:187], v[208:211]
    v_cvt_pk_bf16_f32 v114, v204, v205
    v_cvt_pk_bf16_f32 v115, v206, v207
    v_mfma_f32_16x16x32_bf16 v[212:215], v[140:143], v[184:187], v[212:215]
    v_cndmask_b32_e64 v0, v0, 0, vcc
    v_max3_f32 v252, v164, v165, v166
    v_mfma_f32_16x16x32_bf16 v[216:219], v[148:151], v[184:187], v[216:219]
    s_waitcnt lgkmcnt(10)
    v_rcp_f32 v188, v188
    v_mfma_f32_16x16x32_bf16 v[196:199], a[0:3], v[224:227], 0
    s_waitcnt lgkmcnt(9)
    v_mul_f32 v208, v188, v208
    v_mul_f32 v209, v188, v209
    v_mfma_f32_16x16x32_bf16 v[196:199], a[4:7], v[228:231], v[196:199]
    s_waitcnt lgkmcnt(8)
    v_cvt_pk_bf16_f32 v208, v208, v209
    v_mul_f32 v210, v188, v210
    v_mfma_f32_16x16x32_bf16 v[196:199], a[8:11], v[232:235], v[196:199]
    v_mul_f32 v211, v188, v211
    v_cvt_pk_bf16_f32 v209, v210, v211
    v_mfma_f32_16x16x32_bf16 v[200:203], a[24:27], v[224:227], 0
    v_mul_f32 v212, v188, v212
    v_mul_f32 v213, v188, v213
    v_mfma_f32_16x16x32_bf16 v[200:203], a[28:31], v[228:231], v[200:203]
    v_cvt_pk_bf16_f32 v210, v212, v213
    v_mul_f32 v214, v188, v214
    v_mfma_f32_16x16x32_bf16 v[200:203], a[32:35], v[232:235], v[200:203]
    v_mul_f32 v215, v188, v215
    v_cvt_pk_bf16_f32 v211, v214, v215
    v_mfma_f32_16x16x32_bf16 v[204:207], a[48:51], v[224:227], 0
    ds_write_b128 v8, v[208:211] offset:31488
    v_mfma_f32_16x16x32_bf16 v[204:207], a[52:55], v[228:231], v[204:207]
    ds_read_b128 v[224:227], v7 offset:17408
    v_mul_f32 v216, v188, v216
    v_mfma_f32_16x16x32_bf16 v[204:207], a[56:59], v[232:235], v[204:207]
    s_waitcnt lgkmcnt(9)
    ds_read_b128 v[208:211], v17 offset:3072
    v_mul_f32 v217, v188, v217
    v_mfma_f32_16x16x32_bf16 v[204:207], a[60:63], v[236:239], v[204:207]
    s_waitcnt lgkmcnt(9)
    v_cvt_pk_bf16_f32 v212, v216, v217
    v_mul_f32 v218, v188, v218
    v_mfma_f32_16x16x32_bf16 v[204:207], a[64:67], v[220:223], v[204:207]
    v_mul_f32 v219, v188, v219
    v_cvt_pk_bf16_f32 v213, v218, v219
    v_mfma_f32_16x16x32_bf16 v[200:203], a[36:39], v[236:239], v[200:203]
    ds_write_b64 v9, v[212:213] offset:31488
    v_mfma_f32_16x16x32_bf16 v[200:203], a[40:43], v[220:223], v[200:203]
    ds_read_b128 v[212:215], v17 offset:4096
    ds_read_b128 v[216:219], v17 offset:5120
    v_mfma_f32_16x16x32_bf16 v[196:199], a[12:15], v[236:239], v[196:199]
    s_waitcnt lgkmcnt(4)
    v_lshl_add_u32 v248, v7, 1, s19
    v_cmp_gt_u32 vcc, s64, v16
    v_mfma_f32_16x16x32_bf16 v[204:207], a[68:71], v[224:227], v[204:207]
    v_mov_b32 v163, 0x80000000
    v_cndmask_b32 v16, v163, v16, vcc
    v_mfma_f32_16x16x32_bf16 v[200:203], a[44:47], v[224:227], v[200:203]
    s_mov_b64 vcc, 0
    s_mov_b32 vcc_hi, 0xffff
    v_mfma_f32_16x16x32_bf16 v[196:199], a[16:19], v[220:223], v[196:199]
    s_nop 1
    v_cvt_pk_bf16_f32 v120, v204, v205
    v_mfma_f32_16x16x32_bf16 v[196:199], a[20:23], v[224:227], v[196:199]
    s_waitcnt vmcnt(0) lgkmcnt(2)
    s_barrier
    v_mfma_f32_16x16x32_bf16 v[168:171], v[110:113], v[152:155], 0
    ds_read_b128 v[180:183], v7 offset:21248
    ds_read_b128 v[184:187], v7 offset:27392
    v_mfma_f32_16x16x32_bf16 v[176:179], v[122:125], v[152:155], v[0:3]
    ds_read_b128 v[188:191], v7 offset:33536
    v_cvt_pk_bf16_f32 v118, v200, v201
    v_cvt_pk_bf16_f32 v116, v196, v197
    v_mfma_f32_16x16x16_bf16 v[168:171], v[114:115], v[156:157], v[168:171]
    ds_read_b128 v[192:195], v7 offset:22272
    v_cvt_pk_bf16_f32 v117, v198, v199
    v_mfma_f32_16x16x16_bf16 v[176:179], v[126:127], v[156:157], v[176:179]
    ds_read_b128 v[220:223], v7 offset:28416
    v_cvt_pk_bf16_f32 v119, v202, v203
    v_cvt_pk_bf16_f32 v121, v206, v207
    s_nop 0
    v_mfma_f32_16x16x32_bf16 v[172:175], v[116:119], v[152:155], 0
    s_waitcnt lgkmcnt(4)
    ds_read_b128 v[224:227], v7 offset:34560
    ds_read_b128 v[228:231], v7 offset:19200
    v_max3_f32 v253, v167, v168, v169
    v_max3_f32 v252, v252, v170, v171
    v_mfma_f32_16x16x32_bf16 v[32:35], v[128:131], v[180:183], v[32:35]
    ds_read_b128 v[232:235], v7 offset:20224
    ds_read_b128 v[236:239], v7 offset:23296
    v_mfma_f32_16x16x16_bf16 v[172:175], v[120:121], v[156:157], v[172:175]
    s_waitcnt lgkmcnt(7)
    ds_read_b128 v[196:199], v17 offset:0
    v_mfma_f32_16x16x32_bf16 v[44:47], v[128:131], v[184:187], v[44:47]
    s_waitcnt lgkmcnt(7)
    ds_read_b128 v[200:203], v17 offset:1024
    v_mfma_f32_16x16x32_bf16 v[56:59], v[128:131], v[188:191], v[56:59]
    ds_read_b64_tr_b16 v[128:129], v18 offset:4640
    v_mfma_f32_16x16x32_bf16 v[36:39], v[136:139], v[180:183], v[36:39]
    ds_read_b64_tr_b16 v[130:131], v18 offset:6176
    ds_read_b128 v[204:207], v17 offset:2048
    v_mfma_f32_16x16x32_bf16 v[48:51], v[136:139], v[184:187], v[48:51]
    v_max3_f32 v253, v253, v172, v173
    v_max3_f32 v252, v252, v174, v175
    v_mfma_f32_16x16x32_bf16 v[60:63], v[136:139], v[188:191], v[60:63]
    ds_read_b64_tr_b16 v[136:137], v18 offset:4672
    ds_read_b64_tr_b16 v[138:139], v18 offset:6208
    v_mfma_f32_16x16x32_bf16 v[40:43], v[144:147], v[180:183], v[40:43]
    ds_read_b128 v[180:183], v7 offset:24320
    v_max3_f32 v252, v252, v253, v176
    v_mfma_f32_16x16x32_bf16 v[52:55], v[144:147], v[184:187], v[52:55]
    ds_read_b128 v[184:187], v7 offset:30464
    v_mov_b32 v253, v252
    v_mfma_f32_16x16x32_bf16 v[64:67], v[144:147], v[188:191], v[64:67]
    s_waitcnt lgkmcnt(13)
    ds_read_b64_tr_b16 v[144:145], v18 offset:3072
    ds_read_b64_tr_b16 v[146:147], v18 offset:7680
    v_mfma_f32_16x16x32_bf16 v[32:35], v[158:161], v[192:195], v[32:35]
    ds_read_b128 v[188:191], v7 offset:36608
    v_permlane16_swap_b32 v252, v253
    v_mfma_f32_16x16x32_bf16 v[44:47], v[158:161], v[220:223], v[44:47]
    s_waitcnt lgkmcnt(15)
    v_max_f32 v252, v252, v253
    v_mov_b32 v253, v252
    v_mfma_f32_16x16x32_bf16 v[56:59], v[158:161], v[224:227], v[56:59]
    s_waitcnt lgkmcnt(8)
    ds_read_b64_tr_b16 v[158:159], v18 offset:3104
    ds_read_b64_tr_b16 v[160:161], v18 offset:7712
    v_mfma_f32_16x16x32_bf16 v[36:39], v[128:131], v[192:195], v[36:39]
    v_permlane32_swap_b32 v252, v253
    v_mfma_f32_16x16x32_bf16 v[48:51], v[128:131], v[220:223], v[48:51]
    v_max_f32 v252, v252, v253
    v_mul_f32 v252, s54, v252
    v_mfma_f32_16x16x32_bf16 v[60:63], v[128:131], v[224:227], v[60:63]
    s_waitcnt lgkmcnt(7)
    ds_read_b64_tr_b16 v[128:129], v18 offset:3136
    ds_read_b64_tr_b16 v[130:131], v18 offset:7744
    v_mfma_f32_16x16x32_bf16 v[40:43], v[136:139], v[192:195], v[40:43]
    ds_read_b128 v[192:195], v1 offset:4160
    s_andn2_b64 exec, -1, s[80:81]
    v_mov_b32 v252, 0x7f800000
    s_mov_b64 exec, -1
    v_mfma_f32_16x16x32_bf16 v[52:55], v[136:139], v[220:223], v[52:55]
    ds_read_b128 v[220:223], v7 offset:25344
    v_fma_f32 v164, v164, s54, -v252
    v_mfma_f32_16x16x32_bf16 v[64:67], v[136:139], v[224:227], v[64:67]
    s_waitcnt lgkmcnt(7)
    ds_read_b128 v[224:227], v7 offset:26368
    ds_read_b128 v[136:139], v4 offset:7488
    v_mfma_f32_16x16x32_bf16 v[32:35], v[144:147], v[180:183], v[32:35]
    v_fma_f32 v165, v165, s54, -v252
    v_fma_f32 v166, v166, s54, -v252
    v_mfma_f32_16x16x32_bf16 v[44:47], v[144:147], v[184:187], v[44:47]
    s_waitcnt lgkmcnt(8)
    v_fma_f32 v167, v167, s54, -v252
    v_fma_f32 v168, v168, s54, -v252
    v_mfma_f32_16x16x32_bf16 v[56:59], v[144:147], v[188:191], v[56:59]
    s_waitcnt lgkmcnt(6)
    ds_read_b128 v[144:147], v4 offset:7520
    v_fma_f32 v169, v169, s54, -v252
    v_mfma_f32_16x16x32_bf16 v[36:39], v[158:161], v[180:183], v[36:39]
    v_fma_f32 v170, v170, s54, -v252
    v_fma_f32 v171, v171, s54, -v252
    v_mfma_f32_16x16x32_bf16 v[48:51], v[158:161], v[184:187], v[48:51]
    v_fma_f32 v172, v172, s54, -v252
    v_fma_f32 v173, v173, s54, -v252
    v_mfma_f32_16x16x32_bf16 v[60:63], v[158:161], v[188:191], v[60:63]
    s_waitcnt lgkmcnt(5)
    ds_read_b128 v[158:161], v4 offset:7552
    v_fma_f32 v174, v174, s54, -v252
    v_mfma_f32_16x16x32_bf16 v[40:43], v[128:131], v[180:183], v[40:43]
    ds_read_b128 v[180:183], v1 offset:0
    v_fma_f32 v175, v175, s54, -v252
    v_mfma_f32_16x16x32_bf16 v[52:55], v[128:131], v[184:187], v[52:55]
    ds_read_b128 v[184:187], v1 offset:416
    v_fma_f32 v176, v176, s54, -v252
    v_mfma_f32_16x16x32_bf16 v[64:67], v[128:131], v[188:191], v[64:67]
    ds_read_b128 v[188:191], v1 offset:832
    ds_read_b128 v[128:131], v5 offset:7488
    v_mfma_f32_16x16x32_bf16 v[32:35], a[216:219], v[228:231], v[32:35]
    v_exp_f32 v164, v164
    v_mfma_f32_16x16x32_bf16 v[32:35], a[220:223], v[232:235], v[32:35]
    v_exp_f32 v165, v165
    v_mfma_f32_16x16x32_bf16 v[32:35], a[224:227], v[236:239], v[32:35]
    v_exp_f32 v166, v166
    v_mfma_f32_16x16x32_bf16 v[36:39], a[228:231], v[228:231], v[36:39]
    v_cvt_pk_bf16_f32 v164, v164, v165
    v_exp_f32 v167, v167
    v_mfma_f32_16x16x32_bf16 v[36:39], a[232:235], v[232:235], v[36:39]
    v_exp_f32 v168, v168
    v_mfma_f32_16x16x32_bf16 v[36:39], a[236:239], v[236:239], v[36:39]
    v_cvt_pk_bf16_f32 v165, v166, v167
    v_exp_f32 v169, v169
    v_mfma_f32_16x16x32_bf16 v[40:43], a[240:243], v[228:231], v[40:43]
    ds_read_b128 v[228:231], v7 offset:29440
    v_exp_f32 v170, v170
    v_mfma_f32_16x16x32_bf16 v[40:43], a[244:247], v[232:235], v[40:43]
    ds_read_b128 v[232:235], v7 offset:31488
    v_cvt_pk_bf16_f32 v166, v168, v169
    v_mfma_f32_16x16x32_bf16 v[40:43], a[248:251], v[236:239], v[40:43]
    s_waitcnt lgkmcnt(10)
    ds_read_b128 v[236:239], v7 offset:32512
    v_exp_f32 v171, v171
    v_mfma_f32_16x16x32_bf16 v[44:47], a[216:219], v[220:223], v[44:47]
    s_waitcnt lgkmcnt(10)
    v_exp_f32 v172, v172
    v_mfma_f32_16x16x32_bf16 v[44:47], a[220:223], v[224:227], v[44:47]
    v_cvt_pk_bf16_f32 v167, v170, v171
    v_exp_f32 v173, v173
    v_mfma_f32_16x16x32_bf16 v[48:51], a[228:231], v[220:223], v[48:51]
    s_waitcnt lgkmcnt(2)
    v_exp_f32 v174, v174
    v_mfma_f32_16x16x32_bf16 v[44:47], a[224:227], v[228:231], v[44:47]
    v_cvt_pk_bf16_f32 v168, v172, v173
    v_exp_f32 v175, v175
    v_mfma_f32_16x16x32_bf16 v[48:51], a[232:235], v[224:227], v[48:51]
    v_exp_f32 v176, v176
    v_mfma_f32_16x16x32_bf16 v[48:51], a[236:239], v[228:231], v[48:51]
    v_cvt_pk_bf16_f32 v169, v174, v175
    v_mov_b32 v171, 0
    v_mfma_f32_16x16x32_bf16 v[52:55], a[240:243], v[220:223], v[52:55]
    ds_read_b128 v[220:223], v7 offset:35584
    ds_read_b128 v[172:175], v1 offset:32
    v_mfma_f32_16x16x32_bf16 v[52:55], a[244:247], v[224:227], v[52:55]
    ds_read_b128 v[224:227], v7 offset:0
    v_cvt_pk_bf16_f32 v170, v176, 0
    v_mfma_f32_16x16x32_bf16 v[52:55], a[248:251], v[228:231], v[52:55]
    s_waitcnt lgkmcnt(4)
    ds_read_b128 v[176:179], v1 offset:448
    v_cvt_pk_bf16_f32 v32, v32, v33
    v_mfma_f32_16x16x32_bf16 v[56:59], a[216:219], v[232:235], v[56:59]
    s_waitcnt lgkmcnt(4)
    ds_read_b128 v[228:231], v7 offset:1024
    v_cvt_pk_bf16_f32 v33, v34, v35
    v_mfma_f32_16x16x32_bf16 v[56:59], a[220:223], v[236:239], v[56:59]
    ds_write_b64 v12, v[32:33] offset:37632
    v_mfma_f32_16x16x32_bf16 v[60:63], a[228:231], v[232:235], v[60:63]
    s_waitcnt lgkmcnt(5)
    v_cvt_pk_bf16_f32 v36, v36, v37
    v_cvt_pk_bf16_f32 v37, v38, v39
    v_mfma_f32_16x16x32_bf16 v[56:59], a[224:227], v[220:223], v[56:59]
    v_cvt_pk_bf16_f32 v40, v40, v41
    v_cvt_pk_bf16_f32 v41, v42, v43
    v_mfma_f32_16x16x32_bf16 v[60:63], a[232:235], v[236:239], v[60:63]
    v_cvt_pk_bf16_f32 v44, v44, v45
    v_cvt_pk_bf16_f32 v45, v46, v47
    v_mfma_f32_16x16x32_bf16 v[60:63], a[236:239], v[220:223], v[60:63]
    v_cvt_pk_bf16_f32 v48, v48, v49
    v_cvt_pk_bf16_f32 v49, v50, v51
    v_mfma_f32_16x16x32_bf16 v[64:67], a[240:243], v[232:235], v[64:67]
    ds_read_b128 v[232:235], v7 offset:2048
    v_cvt_pk_bf16_f32 v52, v52, v53
    v_mfma_f32_16x16x32_bf16 v[64:67], a[244:247], v[236:239], v[64:67]
    ds_write_b64 v12, v[36:37] offset:37664
    v_mfma_f32_16x16x32_bf16 v[64:67], a[248:251], v[220:223], v[64:67]
    ds_read_b128 v[236:239], v7 offset:3072
    ds_read_b128 v[220:223], v7 offset:4096
    v_mfma_f32_16x16x32_bf16 v[32:35], v[20:23], v[136:139], 0
    ds_read_b128 v[136:139], v5 offset:7520
    v_cvt_pk_bf16_f32 v53, v54, v55
    v_mfma_f32_16x16x32_bf16 v[36:39], v[24:27], v[144:147], 0
    ds_read_b128 v[144:147], v5 offset:7552
    v_cvt_pk_bf16_f32 v56, v56, v57
    v_cvt_pk_bf16_f32 v57, v58, v59
    v_smfmac_f32_16x16x64_bf16 v[32:35], v[196:199], v[180:187], v19
    ds_read_b128 v[180:183], v1 offset:864
    v_cvt_pk_bf16_f32 v60, v60, v61
    v_smfmac_f32_16x16x64_bf16 v[32:35], v[200:203], v[188:195], v19
    s_waitcnt lgkmcnt(9)
    ds_read_b128 v[184:187], v1 offset:4192
    v_cvt_pk_bf16_f32 v61, v62, v63
    v_smfmac_f32_16x16x64_bf16 v[36:39], v[204:207], v[172:179], v19
    ds_write_b64 v12, v[40:41] offset:37696
    v_mfma_f32_16x16x32_bf16 v[40:43], v[28:31], v[158:161], 0
    ds_read_b128 v[188:191], v1 offset:64
    v_cvt_pk_bf16_f32 v64, v64, v65
    v_cvt_pk_bf16_f32 v65, v66, v67
    ds_read_b128 v[192:195], v1 offset:480
    ds_read_b128 v[172:175], v1 offset:896
    v_add_f32 v240, v32, v33
    ds_read_b128 v[176:179], v1 offset:4224
    v_mul_f32 v241, v32, v32
    v_fmac_f32 v241, v33, v33
    v_add_f32 v240, v240, v34
    v_fmac_f32 v241, v34, v34
    v_add_f32 v240, v240, v35
    ds_write_b64 v12, v[44:45] offset:44032
    s_waitcnt lgkmcnt(6)
    v_smfmac_f32_16x16x64_bf16 v[36:39], v[208:211], v[180:187], v19
    ds_read_b128 v[180:183], v2 offset:0
    ds_read_b128 v[184:187], v2 offset:416
    v_mfma_f32_16x16x32_bf16 v[44:47], v[20:23], v[128:131], 0
    s_waitcnt lgkmcnt(5)
    ds_read_b128 v[158:161], v6 offset:7488
    v_fmac_f32 v241, v35, v35
    v_smfmac_f32_16x16x64_bf16 v[40:43], v[212:215], v[188:195], v19
    s_waitcnt lgkmcnt(4)
    ds_read_b128 v[188:191], v2 offset:832
    v_add_f32 v240, v240, v36
    v_fmac_f32 v241, v36, v36
    v_add_f32 v240, v240, v37
    v_fmac_f32 v241, v37, v37
    v_add_f32 v240, v240, v38
    v_smfmac_f32_16x16x64_bf16 v[40:43], v[216:219], v[172:179], v19
    ds_read_b128 v[192:195], v2 offset:4160
    ds_write_b64 v12, v[48:49] offset:44064
    v_mfma_f32_16x16x32_bf16 v[48:51], v[24:27], v[136:139], 0
    s_waitcnt lgkmcnt(4)
    ds_read_b128 v[172:175], v2 offset:32
    v_fmac_f32 v241, v38, v38
    v_add_f32 v240, v240, v39
    v_fmac_f32 v241, v39, v39
    s_nop 0
    v_add_f32 v240, v240, v40
    v_smfmac_f32_16x16x64_bf16 v[44:47], v[196:199], v[180:187], v19
    ds_read_b128 v[176:179], v2 offset:448
    ds_read_b128 v[180:183], v2 offset:864
    v_fmac_f32 v241, v40, v40
    v_add_f32 v240, v240, v41
    v_fmac_f32 v241, v41, v41
    v_add_f32 v240, v240, v42
    v_fmac_f32 v241, v42, v42
    v_add_f32 v240, v240, v43
    ds_write_b64 v12, v[52:53] offset:44096
    s_waitcnt lgkmcnt(5)
    v_smfmac_f32_16x16x64_bf16 v[44:47], v[200:203], v[188:195], v19
    ds_read_b128 v[184:187], v2 offset:4192
    ds_read_b128 v[188:191], v2 offset:64
    v_mfma_f32_16x16x32_bf16 v[52:55], v[28:31], v[144:147], 0
    s_waitcnt lgkmcnt(4)
    ds_read_b128 v[192:195], v2 offset:480
    v_fmac_f32 v241, v43, v43
    v_smfmac_f32_16x16x64_bf16 v[48:51], v[204:207], v[172:179], v19
    ds_read_b128 v[172:175], v2 offset:896
    v_permlane16_swap_b32 v240, v241
    v_add_f32 v240, v240, v241
    ds_read_b128 v[176:179], v2 offset:4224
    ds_read_b128 v[128:131], v6 offset:7520
    ds_write_b64 v12, v[56:57] offset:50432
    v_mfma_f32_16x16x32_bf16 v[56:59], v[20:23], v[158:161], 0
    s_waitcnt lgkmcnt(6)
    v_add_f32 v242, v44, v45
    v_mul_f32 v243, v44, v44
    v_smfmac_f32_16x16x64_bf16 v[48:51], v[208:211], v[180:187], v19
    s_waitcnt lgkmcnt(4)
    ds_read_b128 v[180:183], v3 offset:0
    ds_read_b128 v[184:187], v3 offset:416
    v_fmac_f32 v243, v45, v45
    v_smfmac_f32_16x16x64_bf16 v[52:55], v[212:215], v[188:195], v19
    s_waitcnt lgkmcnt(4)
    ds_read_b128 v[188:191], v3 offset:832
    v_add_f32 v242, v242, v46
    v_fmac_f32 v243, v46, v46
    v_add_f32 v242, v242, v47
    v_fmac_f32 v243, v47, v47
    v_add_f32 v242, v242, v48
    v_smfmac_f32_16x16x64_bf16 v[52:55], v[216:219], v[172:179], v19
    s_waitcnt lgkmcnt(4)
    ds_read_b128 v[192:195], v3 offset:4160
    ds_write_b64 v12, v[60:61] offset:50464
    v_mfma_f32_16x16x32_bf16 v[60:63], v[24:27], v[128:131], 0
    ds_read_b128 v[172:175], v3 offset:32
    v_fmac_f32 v243, v48, v48
    v_add_f32 v242, v242, v49
    v_fmac_f32 v243, v49, v49
    v_add_f32 v242, v242, v50
    v_fmac_f32 v243, v50, v50
    v_add_f32 v242, v242, v51
    v_fmac_f32 v243, v51, v51
    v_add_f32 v242, v242, v52
    v_fmac_f32 v243, v52, v52
    s_waitcnt lgkmcnt(4)
    v_smfmac_f32_16x16x64_bf16 v[56:59], v[196:199], v[180:187], v19
    s_waitcnt lgkmcnt(2)
    ds_read_b128 v[176:179], v3 offset:448
    ds_read_b128 v[180:183], v3 offset:864
    v_add_f32 v242, v242, v53
    ds_write_b64 v12, v[64:65] offset:50496
    v_smfmac_f32_16x16x64_bf16 v[56:59], v[200:203], v[188:195], v19
    ds_read_b128 v[184:187], v3 offset:4192
    v_fmac_f32 v243, v53, v53
    v_add_f32 v242, v242, v54
    v_fmac_f32 v243, v54, v54
    v_add_f32 v242, v242, v55
    v_fmac_f32 v243, v55, v55
    ds_read_b128 v[136:139], v6 offset:7552
    ds_read_b128 v[188:191], v3 offset:64
    v_permlane16_swap_b32 v242, v243
    v_add_f32 v242, v242, v243
    s_waitcnt lgkmcnt(5)
    v_smfmac_f32_16x16x64_bf16 v[60:63], v[204:207], v[172:179], v19
    ds_read_b128 v[192:195], v3 offset:480
    ds_read_b128 v[172:175], v3 offset:896
    v_permlane32_swap_b32 v240, v242
    v_add_f32 v240, v240, v242
    ds_write_b32 v10, v240 offset:0
    ds_read_b128 v[176:179], v3 offset:4224
    v_add_f32 v244, v56, v57
    s_waitcnt lgkmcnt(6)
    v_smfmac_f32_16x16x64_bf16 v[60:63], v[208:211], v[180:187], v19
    s_waitcnt lgkmcnt(5)
    v_mul_f32 v245, v56, v56
    v_fmac_f32 v245, v57, v57
    v_mfma_f32_16x16x32_bf16 v[64:67], v[28:31], v[136:139], 0
    v_add_f32 v244, v244, v58
    v_fmac_f32 v245, v58, v58
    v_mfma_f32_16x16x32_bf16 v[208:211], v[224:227], a[144:147], 0
    v_add_f32 v244, v244, v59
    v_fmac_f32 v245, v59, v59
    v_mfma_f32_16x16x32_bf16 v[208:211], v[228:231], a[148:151], v[208:211]
    s_waitcnt lgkmcnt(3)
    v_add_f32 v244, v244, v60
    v_fmac_f32 v245, v60, v60
    v_smfmac_f32_16x16x64_bf16 v[64:67], v[212:215], v[188:195], v19
    v_add_f32 v244, v244, v61
    v_fmac_f32 v245, v61, v61
    v_mfma_f32_16x16x32_bf16 v[208:211], v[232:235], a[152:155], v[208:211]
    s_waitcnt lgkmcnt(0)
    v_add_f32 v244, v244, v62
    v_fmac_f32 v245, v62, v62
    v_smfmac_f32_16x16x64_bf16 v[64:67], v[216:219], v[172:179], v19
    v_add_f32 v244, v244, v63
    v_fmac_f32 v245, v63, v63
    v_mfma_f32_16x16x32_bf16 v[212:215], v[224:227], a[168:171], 0
    v_mfma_f32_16x16x32_bf16 v[212:215], v[228:231], a[172:175], v[212:215]
    v_mfma_f32_16x16x32_bf16 v[212:215], v[232:235], a[176:179], v[212:215]
    v_mfma_f32_16x16x32_bf16 v[216:219], v[224:227], a[192:195], 0
    ds_read_b128 v[224:227], v7 offset:5120
    v_mfma_f32_16x16x32_bf16 v[216:219], v[228:231], a[196:199], v[216:219]
    ds_read_b128 v[228:231], v7 offset:6144
    v_add_f32 v244, v244, v64
    v_mfma_f32_16x16x32_bf16 v[216:219], v[232:235], a[200:203], v[216:219]
    ds_read_b128 v[232:235], v7 offset:7168
    v_fmac_f32 v245, v64, v64
    v_mfma_f32_16x16x32_bf16 v[216:219], v[236:239], a[204:207], v[216:219]
    v_add_f32 v244, v244, v65
    v_fmac_f32 v245, v65, v65
    v_mfma_f32_16x16x32_bf16 v[216:219], v[220:223], a[208:211], v[216:219]
    v_add_f32 v244, v244, v66
    v_fmac_f32 v245, v66, v66
    v_mfma_f32_16x16x32_bf16 v[212:215], v[236:239], a[180:183], v[212:215]
    v_add_f32 v244, v244, v67
    v_fmac_f32 v245, v67, v67
    v_mfma_f32_16x16x32_bf16 v[212:215], v[220:223], a[184:187], v[212:215]
    s_nop 0
    v_permlane16_swap_b32 v244, v245
    s_waitcnt lgkmcnt(2)
    v_mfma_f32_16x16x32_bf16 v[216:219], v[224:227], a[212:215], v[216:219]
    v_add_f32 v244, v244, v245
    v_mov_b32 v246, v244
    v_mfma_f32_16x16x32_bf16 v[212:215], v[224:227], a[188:191], v[212:215]
    s_nop 0
    v_permlane32_swap_b32 v244, v246
    v_mfma_f32_16x16x32_bf16 v[208:211], v[236:239], a[156:159], v[208:211]
    ds_read_b128 v[236:239], v7 offset:8192
    v_add_f32 v244, v244, v246
    v_mfma_f32_16x16x32_bf16 v[208:211], v[220:223], a[160:163], v[208:211]
    ds_write_b32 v10, v244 offset:1024
    v_mfma_f32_16x16x32_bf16 v[208:211], v[224:227], a[164:167], v[208:211]
    s_waitcnt lgkmcnt(3)
    ds_read_b128 v[220:223], v7 offset:9216
    ds_read_b128 v[224:227], v7 offset:10240
    v_mfma_f32_16x16x32_bf16 v[196:199], v[228:231], a[144:147], 0
    s_waitcnt lgkmcnt(4)
    v_cvt_pk_bf16_f32 v136, v212, v213
    v_cvt_pk_bf16_f32 v137, v214, v215
    v_mfma_f32_16x16x32_bf16 v[196:199], v[232:235], a[148:151], v[196:199]
    v_cvt_pk_bf16_f32 v128, v208, v209
    v_cvt_pk_bf16_f32 v129, v210, v211
    v_mfma_f32_16x16x32_bf16 v[200:203], v[228:231], a[168:171], 0
    v_cvt_pk_bf16_f32 v144, v216, v217
    v_cvt_pk_bf16_f32 v145, v218, v219
    v_mfma_f32_16x16x32_bf16 v[200:203], v[232:235], a[172:175], v[200:203]
    s_waitcnt lgkmcnt(3)
    v_mfma_f32_16x16x32_bf16 v[196:199], v[236:239], a[152:155], v[196:199]
    s_waitcnt lgkmcnt(2)
    s_barrier
    v_mfma_f32_16x16x32_bf16 v[200:203], v[236:239], a[176:179], v[200:203]
    ds_read_b128 v[240:243], v248 offset:0
    ds_read_b128 v[244:247], v248 offset:16
    v_mfma_f32_16x16x32_bf16 v[204:207], v[228:231], a[192:195], 0
    ds_read_b128 v[180:183], v13 offset:37632
    v_mfma_f32_16x16x32_bf16 v[204:207], v[232:235], a[196:199], v[204:207]
    ds_read_b128 v[184:187], v13 offset:37760
    v_mfma_f32_16x16x32_bf16 v[204:207], v[236:239], a[200:203], v[204:207]
    s_waitcnt lgkmcnt(5)
    ds_read_b128 v[188:191], v13 offset:37888
    v_mfma_f32_16x16x32_bf16 v[204:207], v[220:223], a[204:207], v[204:207]
    s_waitcnt lgkmcnt(5)
    ds_read_b128 v[192:195], v13 offset:38032
    v_mfma_f32_16x16x32_bf16 v[204:207], v[224:227], a[208:211], v[204:207]
    ds_read_b128 v[172:175], v13 offset:38160
    v_mfma_f32_16x16x32_bf16 v[200:203], v[220:223], a[180:183], v[200:203]
    s_waitcnt lgkmcnt(6)
    ds_read_b128 v[176:179], v13 offset:38288
    v_add_f32 v240, v240, v241
    v_mfma_f32_16x16x32_bf16 v[200:203], v[224:227], a[184:187], v[200:203]
    ds_read_b128 v[228:231], v7 offset:11264
    v_add_f32 v242, v242, v243
    v_mfma_f32_16x16x32_bf16 v[196:199], v[220:223], a[156:159], v[196:199]
    s_waitcnt lgkmcnt(6)
    buffer_store_dwordx4 v[180:183], v14, s[40:43], s88 offen offset:0 sc1
    v_mfma_f32_16x16x32_bf16 v[196:199], v[224:227], a[160:163], v[196:199]
    ds_read_b128 v[232:235], v7 offset:12288
    ds_read_b128 v[236:239], v7 offset:13312
    v_add_f32 v244, v244, v245
    v_add_f32 v246, v246, v247
    v_add_f32 v240, v240, v242
    v_add_f32 v244, v244, v246
    v_mul_f32 v240, s59, v240
    v_fma_f32 v241, v240, v240, -s60
    v_fma_f32 v244, v244, s59, -v241
    v_max_f32 v244, s60, v244
    v_rsq_f32 v248, v244
    s_waitcnt lgkmcnt(3)
    s_barrier
    s_waitcnt lgkmcnt(2)
    v_mfma_f32_16x16x32_bf16 v[204:207], v[228:231], a[212:215], v[204:207]
    buffer_store_dwordx4 v[184:187], v14, s[40:43], s88 offen offset:128 sc1
    v_mfma_f32_16x16x32_bf16 v[200:203], v[228:231], a[188:191], v[200:203]
    ds_bpermute_b32 v254, v11, v248 offset:0
    v_mfma_f32_16x16x32_bf16 v[196:199], v[228:231], a[164:167], v[196:199]
    s_waitcnt lgkmcnt(2)
    ds_bpermute_b32 v250, v11, v248 offset:64
    v_mfma_f32_16x16x32_bf16 v[208:211], v[232:235], a[144:147], 0
    s_waitcnt lgkmcnt(2)
    ds_read_b128 v[220:223], v7 offset:14336
    ds_read_b128 v[224:227], v7 offset:15360
    v_mfma_f32_16x16x32_bf16 v[208:211], v[236:239], a[148:151], v[208:211]
    buffer_store_dwordx4 v[188:191], v14, s[40:43], s88 offen offset:256 sc1
    v_mfma_f32_16x16x32_bf16 v[212:215], v[232:235], a[168:171], 0
    ds_read_b128 v[228:231], v7 offset:16384
    v_mul_f32 v249, v240, v248
    v_mfma_f32_16x16x32_bf16 v[212:215], v[236:239], a[172:175], v[212:215]
    ds_bpermute_b32 v255, v11, v249 offset:0
    v_mfma_f32_16x16x32_bf16 v[216:219], v[232:235], a[192:195], 0
    ds_bpermute_b32 v251, v11, v249 offset:64
    v_mfma_f32_16x16x32_bf16 v[216:219], v[236:239], a[196:199], v[216:219]
    s_waitcnt lgkmcnt(4)
    buffer_store_dwordx4 v[192:195], v15, s[40:43], s88 offen offset:384 sc1
    v_mfma_f32_16x16x32_bf16 v[208:211], v[220:223], a[152:155], v[208:211]
    ds_read_b128 v[232:235], v7 offset:17408
    ds_read_b128 v[236:239], v7 offset:0
    v_mfma_f32_16x16x32_bf16 v[212:215], v[220:223], a[176:179], v[212:215]
    v_cvt_pk_bf16_f32 v130, v196, v197
    v_cvt_pk_bf16_f32 v131, v198, v199
    v_mfma_f32_16x16x32_bf16 v[216:219], v[220:223], a[200:203], v[216:219]
    s_waitcnt lgkmcnt(3)
    ds_read_b128 v[220:223], v7 offset:1024
    v_fma_f32 v246, v32, v254, -v255
    v_mfma_f32_16x16x32_bf16 v[216:219], v[224:227], a[204:207], v[216:219]
    buffer_store_dwordx4 v[172:175], v15, s[40:43], s88 offen offset:512 sc1
    v_mfma_f32_16x16x32_bf16 v[216:219], v[228:231], a[208:211], v[216:219]
    v_fma_f32 v247, v33, v254, -v255
    v_cvt_pk_bf16_f32 v240, v246, v247
    v_mfma_f32_16x16x32_bf16 v[212:215], v[224:227], a[180:183], v[212:215]
    s_waitcnt lgkmcnt(2)
    v_fma_f32 v246, v34, v254, -v255
    v_fma_f32 v247, v35, v254, -v255
    v_mfma_f32_16x16x32_bf16 v[216:219], v[232:235], a[212:215], v[216:219]
    v_cvt_pk_bf16_f32 v241, v246, v247
    v_fma_f32 v246, v36, v254, -v255
    v_mfma_f32_16x16x32_bf16 v[212:215], v[228:231], a[184:187], v[212:215]
    buffer_store_dwordx4 v[176:179], v15, s[40:43], s88 offen offset:640 sc1
    v_mfma_f32_16x16x32_bf16 v[212:215], v[232:235], a[188:191], v[212:215]
    v_fma_f32 v247, v37, v254, -v255
    v_cvt_pk_bf16_f32 v242, v246, v247
    v_mfma_f32_16x16x32_bf16 v[208:211], v[224:227], a[156:159], v[208:211]
    ds_read_b128 v[224:227], v7 offset:2048
    v_fma_f32 v246, v38, v254, -v255
    v_mfma_f32_16x16x32_bf16 v[208:211], v[228:231], a[160:163], v[208:211]
    ds_read_b128 v[228:231], v7 offset:3072
    v_fma_f32 v247, v39, v254, -v255
    v_mfma_f32_16x16x32_bf16 v[208:211], v[232:235], a[164:167], v[208:211]
    s_waitcnt lgkmcnt(3)
    s_add_u32 m0, s79, 0
    s_add_u32 s18, s91, 0
    buffer_load_dwordx4 v16, s[24:27], s18 offen nt lds
    v_mfma_f32_16x16x32_bf16 v[196:199], a[72:75], v[236:239], 0
    s_waitcnt lgkmcnt(2)
    ds_read_b128 v[232:235], v7 offset:4096
    v_cvt_pk_bf16_f32 v243, v246, v247
    v_mfma_f32_16x16x32_bf16 v[196:199], a[76:79], v[220:223], v[196:199]
    s_waitcnt lgkmcnt(2)
    ds_write_b128 v8, v[240:243] offset:37632
    v_mfma_f32_16x16x32_bf16 v[196:199], a[80:83], v[224:227], v[196:199]
    s_waitcnt lgkmcnt(2)
    v_fma_f32 v246, v40, v254, -v255
    v_fma_f32 v247, v41, v254, -v255
    v_mfma_f32_16x16x32_bf16 v[196:199], a[84:87], v[228:231], v[196:199]
    v_cvt_pk_bf16_f32 v244, v246, v247
    v_fma_f32 v246, v42, v254, -v255
    v_mfma_f32_16x16x32_bf16 v[172:175], a[252:255], v[164:167], 0
    v_fma_f32 v247, v43, v254, -v255
    v_cvt_pk_bf16_f32 v245, v246, v247
    v_mfma_f32_16x16x32_bf16 v[172:175], a[252:255], v[168:171], v[172:175]
    s_waitcnt lgkmcnt(1)
    ds_bpermute_b32 v254, v11, v248 offset:128
    v_mfma_f32_16x16x32_bf16 v[196:199], a[88:91], v[232:235], v[196:199]
    ds_write_b64 v9, v[244:245] offset:37632
    ds_bpermute_b32 v255, v11, v249 offset:128
    v_cvt_pk_bf16_f32 v138, v200, v201
    v_cvt_pk_bf16_f32 v139, v202, v203
    v_mfma_f32_16x16x32_bf16 v[200:203], a[96:99], v[236:239], 0
    v_cvt_pk_bf16_f32 v146, v204, v205
    v_cvt_pk_bf16_f32 v147, v206, v207
    v_mfma_f32_16x16x32_bf16 v[200:203], a[100:103], v[220:223], v[200:203]
    v_fma_f32 v246, v44, v250, -v251
    v_fma_f32 v247, v45, v250, -v251
    v_mfma_f32_16x16x32_bf16 v[200:203], a[104:107], v[224:227], v[200:203]
    v_cvt_pk_bf16_f32 v240, v246, v247
    v_fma_f32 v246, v46, v250, -v251
    v_mfma_f32_16x16x32_bf16 v[204:207], a[120:123], v[236:239], 0
    ds_read_b128 v[236:239], v7 offset:5120
    v_fma_f32 v247, v47, v250, -v251
    v_mfma_f32_16x16x32_bf16 v[204:207], a[124:127], v[220:223], v[204:207]
    ds_read_b128 v[220:223], v7 offset:6144
    s_add_u32 m0, s79, 3744
    s_add_u32 s18, s91, 86016
    buffer_load_dwordx4 v16, s[20:23], s18 offen nt lds
    v_mfma_f32_16x16x32_bf16 v[204:207], a[128:131], v[224:227], v[204:207]
    ds_read_b128 v[224:227], v7 offset:7168
    v_cvt_pk_bf16_f32 v241, v246, v247
    v_mfma_f32_16x16x32_bf16 v[204:207], a[132:135], v[228:231], v[204:207]
    v_fma_f32 v246, v48, v250, -v251
    v_fma_f32 v247, v49, v250, -v251
    v_mfma_f32_16x16x32_bf16 v[204:207], a[136:139], v[232:235], v[204:207]
    v_cvt_pk_bf16_f32 v242, v246, v247
    v_fma_f32 v246, v50, v250, -v251
    v_mfma_f32_16x16x32_bf16 v[200:203], a[108:111], v[228:231], v[200:203]
    s_waitcnt lgkmcnt(2)
    ds_read_b128 v[228:231], v7 offset:8192
    v_fma_f32 v247, v51, v250, -v251
    v_mfma_f32_16x16x32_bf16 v[204:207], a[140:143], v[236:239], v[204:207]
    v_cvt_pk_bf16_f32 v243, v246, v247
    v_fma_f32 v246, v52, v250, -v251
    v_mfma_f32_16x16x32_bf16 v[200:203], a[112:115], v[232:235], v[200:203]
    ds_write_b128 v8, v[240:243] offset:43776
    v_mfma_f32_16x16x32_bf16 v[200:203], a[116:119], v[236:239], v[200:203]
    ds_read_b128 v[232:235], v7 offset:9216
    v_fma_f32 v247, v53, v250, -v251
    v_mfma_f32_16x16x32_bf16 v[196:199], a[92:95], v[236:239], v[196:199]
    ds_read_b128 v[236:239], v7 offset:10240
    v_cvt_pk_bf16_f32 v244, v246, v247
    v_fma_f32 v246, v54, v250, -v251
    v_fma_f32 v247, v55, v250, -v251
    v_cvt_pk_bf16_f32 v245, v246, v247
    v_cvt_pk_bf16_f32 v132, v208, v209
    v_cvt_pk_bf16_f32 v133, v210, v211
    v_mfma_f32_16x16x32_bf16 v[208:211], v[128:131], v[164:167], 0
    v_cvt_pk_bf16_f32 v140, v212, v213
    v_cvt_pk_bf16_f32 v141, v214, v215
    v_mfma_f32_16x16x32_bf16 v[208:211], v[132:135], v[168:171], v[208:211]
    ds_write_b64 v9, v[244:245] offset:43776
    v_mfma_f32_16x16x32_bf16 v[212:215], v[136:139], v[164:167], 0
    v_cvt_pk_bf16_f32 v148, v216, v217
    v_cvt_pk_bf16_f32 v149, v218, v219
    v_mfma_f32_16x16x32_bf16 v[212:215], v[140:143], v[168:171], v[212:215]
    s_add_u32 m0, s79, 7488
    s_add_u32 s18, s91, 172032
    buffer_load_dwordx4 v16, s[20:23], s18 offen nt lds
    v_mfma_f32_16x16x32_bf16 v[216:219], v[144:147], v[164:167], 0
    v_fma_f32 v246, v56, v254, -v255
    v_fma_f32 v247, v57, v254, -v255
    v_mfma_f32_16x16x32_bf16 v[216:219], v[148:151], v[168:171], v[216:219]
    s_waitcnt lgkmcnt(6)
    v_cvt_pk_bf16_f32 v240, v246, v247
    v_fma_f32 v246, v58, v254, -v255
    v_fma_f32 v247, v59, v254, -v255
    v_cvt_pk_bf16_f32 v241, v246, v247
    v_fma_f32 v246, v60, v254, -v255
    v_fma_f32 v247, v61, v254, -v255
    v_cvt_pk_bf16_f32 v242, v246, v247
    v_fma_f32 v246, v62, v254, -v255
    v_fma_f32 v247, v63, v254, -v255
    v_cvt_pk_bf16_f32 v243, v246, v247
    v_fma_f32 v246, v64, v254, -v255
    v_fma_f32 v247, v65, v254, -v255
    v_cvt_pk_bf16_f32 v244, v246, v247
    v_fma_f32 v246, v66, v254, -v255
    v_fma_f32 v247, v67, v254, -v255
    v_cvt_pk_bf16_f32 v245, v246, v247
    ds_write_b128 v8, v[240:243] offset:49920
    v_cvt_pk_bf16_f32 v158, v196, v197
    v_cvt_pk_bf16_f32 v159, v198, v199
    v_mfma_f32_16x16x32_bf16 v[196:199], a[72:75], v[220:223], 0
    s_waitcnt lgkmcnt(6)
    v_cvt_pk_bf16_f32 v160, v200, v201
    v_cvt_pk_bf16_f32 v161, v202, v203
    v_mfma_f32_16x16x32_bf16 v[196:199], a[76:79], v[224:227], v[196:199]
    v_cvt_pk_bf16_f32 v162, v204, v205
    v_cvt_pk_bf16_f32 v163, v206, v207
    v_mfma_f32_16x16x32_bf16 v[180:183], v[104:107], v[158:161], 0
    v_rcp_f32 v172, v172
    v_mfma_f32_16x16x32_bf16 v[184:187], v[110:113], v[158:161], 0
    v_mul_f32 v208, v172, v208
    v_mul_f32 v209, v172, v209
    v_mfma_f32_16x16x32_bf16 v[188:191], v[116:119], v[158:161], 0
    ds_write_b64 v9, v[244:245] offset:49920
    v_mfma_f32_16x16x32_bf16 v[192:195], v[122:125], v[158:161], v[0:3]
    v_cvt_pk_bf16_f32 v208, v208, v209
    s_add_u32 m0, s79, 11232
    s_add_u32 s18, s91, 258048
    buffer_load_dwordx4 v16, s[20:23], s18 offen nt lds
    v_mfma_f32_16x16x16_bf16 v[180:183], v[108:109], v[162:163], v[180:183]
    v_mul_f32 v210, v172, v210
    v_mul_f32 v211, v172, v211
    v_mfma_f32_16x16x16_bf16 v[184:187], v[114:115], v[162:163], v[184:187]
    v_cvt_pk_bf16_f32 v209, v210, v211
    v_mul_f32 v212, v172, v212
    v_mfma_f32_16x16x16_bf16 v[188:191], v[120:121], v[162:163], v[188:191]
    v_mul_f32 v213, v172, v213
    v_cvt_pk_bf16_f32 v210, v212, v213
    v_mfma_f32_16x16x16_bf16 v[192:195], v[126:127], v[162:163], v[192:195]
    s_waitcnt lgkmcnt(0)
    s_barrier
    v_mfma_f32_16x16x32_bf16 v[196:199], a[80:83], v[228:231], v[196:199]
    v_mul_f32 v214, v172, v214
    v_mul_f32 v215, v172, v215
    v_mfma_f32_16x16x32_bf16 v[200:203], a[96:99], v[220:223], 0
    v_cvt_pk_bf16_f32 v211, v214, v215
    v_mul_f32 v216, v172, v216
    v_mfma_f32_16x16x32_bf16 v[200:203], a[100:103], v[224:227], v[200:203]
    s_mov_b64 exec, s[80:81]
    ds_write_b128 v8, v[208:211] offset:56832
    s_mov_b64 exec, -1
    v_mfma_f32_16x16x32_bf16 v[200:203], a[104:107], v[228:231], v[200:203]
    v_mul_f32 v217, v172, v217
    v_cvt_pk_bf16_f32 v212, v216, v217
    v_mfma_f32_16x16x32_bf16 v[204:207], a[120:123], v[220:223], 0
    ds_read_b128 v[220:223], v7 offset:11264
    v_mul_f32 v218, v172, v218
    v_mfma_f32_16x16x32_bf16 v[204:207], a[124:127], v[224:227], v[204:207]
    ds_read_b128 v[224:227], v7 offset:12288
    v_mul_f32 v219, v172, v219
    v_mfma_f32_16x16x32_bf16 v[204:207], a[128:131], v[228:231], v[204:207]
    ds_read_b128 v[228:231], v7 offset:13312
    v_cvt_pk_bf16_f32 v213, v218, v219
    v_mfma_f32_16x16x32_bf16 v[204:207], a[132:135], v[232:235], v[204:207]
    s_mov_b64 exec, s[80:81]
    ds_write_b64 v9, v[212:213] offset:56832
    s_mov_b64 exec, -1
    v_mfma_f32_16x16x32_bf16 v[204:207], a[136:139], v[236:239], v[204:207]
    s_waitcnt lgkmcnt(3)
    s_add_u32 m0, s79, 14976
    s_add_u32 s18, s91, 344064
    buffer_load_dwordx4 v16, s[20:23], s18 offen nt lds
    v_mfma_f32_16x16x32_bf16 v[204:207], a[140:143], v[220:223], v[204:207]
    s_mov_b32 s80, 0x1000100
    v_max3_f32 v254, v180, v181, v182
    v_max3_f32 v255, v183, v184, v185
    v_mfma_f32_16x16x32_bf16 v[200:203], a[108:111], v[232:235], v[200:203]
    s_mov_b32 s81, 0x1000100
    v_max3_f32 v254, v254, v186, v187
    v_max3_f32 v255, v255, v188, v189
    v_mfma_f32_16x16x32_bf16 v[200:203], a[112:115], v[236:239], v[200:203]
    v_cvt_pk_bf16_f32 v162, v204, v205
    v_cvt_pk_bf16_f32 v163, v206, v207
    v_mfma_f32_16x16x32_bf16 v[200:203], a[116:119], v[220:223], v[200:203]
    v_max3_f32 v254, v254, v190, v191
    v_max3_f32 v254, v254, v255, v192
    v_mfma_f32_16x16x32_bf16 v[196:199], a[84:87], v[232:235], v[196:199]
    ds_read_b128 v[232:235], v7 offset:14336
    v_mov_b32 v255, v254
    v_mfma_f32_16x16x32_bf16 v[196:199], a[88:91], v[236:239], v[196:199]
    ds_read_b128 v[236:239], v7 offset:15360
    v_permlane16_swap_b32 v254, v255
    v_mfma_f32_16x16x32_bf16 v[196:199], a[92:95], v[220:223], v[196:199]
    s_waitcnt lgkmcnt(4)
    ds_read_b128 v[220:223], v7 offset:16384
    v_cvt_pk_bf16_f32 v160, v200, v201
    v_mfma_f32_16x16x32_bf16 v[204:207], a[120:123], v[224:227], 0
    v_cvt_pk_bf16_f32 v161, v202, v203
    v_max_f32 v254, v254, v255
    v_mfma_f32_16x16x32_bf16 v[200:203], a[96:99], v[224:227], 0
    s_nop 0
    v_cvt_pk_bf16_f32 v158, v196, v197
    v_cvt_pk_bf16_f32 v159, v198, v199
    v_mfma_f32_16x16x32_bf16 v[196:199], a[72:75], v[224:227], 0
    ds_read_b128 v[224:227], v7 offset:17408
    v_mov_b32 v255, v254
    v_mfma_f32_16x16x32_bf16 v[164:167], v[104:107], v[158:161], 0
    s_nop 0
    v_permlane32_swap_b32 v254, v255
    v_mfma_f32_16x16x32_bf16 v[168:171], v[110:113], v[158:161], 0
    v_max_f32 v254, v254, v255
    v_mul_f32 v254, s54, v254
    v_mfma_f32_16x16x32_bf16 v[172:175], v[116:119], v[158:161], 0
    v_fma_f32 v180, v180, s54, -v254
    v_fma_f32 v181, v181, s54, -v254
    v_mfma_f32_16x16x32_bf16 v[176:179], v[122:125], v[158:161], v[0:3]
    v_fma_f32 v182, v182, s54, -v254
    v_fma_f32 v183, v183, s54, -v254
    v_mfma_f32_16x16x16_bf16 v[164:167], v[108:109], v[162:163], v[164:167]
    s_add_u32 m0, s79, 18720
    s_add_u32 s18, s91, 430080
    buffer_load_dwordx4 v16, s[20:23], s18 offen nt lds
    v_mfma_f32_16x16x16_bf16 v[168:171], v[114:115], v[162:163], v[168:171]
    v_fma_f32 v184, v184, s54, -v254
    v_fma_f32 v185, v185, s54, -v254
    v_mfma_f32_16x16x16_bf16 v[172:175], v[120:121], v[162:163], v[172:175]
    v_fma_f32 v186, v186, s54, -v254
    v_fma_f32 v187, v187, s54, -v254
    v_mfma_f32_16x16x16_bf16 v[176:179], v[126:127], v[162:163], v[176:179]
    s_waitcnt lgkmcnt(5)
    v_fma_f32 v188, v188, s54, -v254
    v_fma_f32 v189, v189, s54, -v254
    v_mfma_f32_16x16x32_bf16 v[196:199], a[76:79], v[228:231], v[196:199]
    s_waitcnt lgkmcnt(3)
    v_fma_f32 v190, v190, s54, -v254
    v_fma_f32 v191, v191, s54, -v254
    v_mfma_f32_16x16x32_bf16 v[196:199], a[80:83], v[232:235], v[196:199]
    v_fma_f32 v192, v192, s54, -v254
    v_exp_f32 v180, v180
    v_mfma_f32_16x16x32_bf16 v[200:203], a[100:103], v[228:231], v[200:203]
    v_exp_f32 v181, v181
    v_mfma_f32_16x16x32_bf16 v[200:203], a[104:107], v[232:235], v[200:203]
    v_exp_f32 v182, v182
    v_mfma_f32_16x16x32_bf16 v[204:207], a[124:127], v[228:231], v[204:207]
    ds_read_b128 v[228:231], v7 offset:37632
    v_cvt_pk_bf16_f32 v180, v180, v181
    v_mfma_f32_16x16x32_bf16 v[204:207], a[128:131], v[232:235], v[204:207]
    s_waitcnt lgkmcnt(3)
    ds_read_b128 v[232:235], v7 offset:38656
    v_exp_f32 v183, v183
    v_mfma_f32_16x16x32_bf16 v[204:207], a[132:135], v[236:239], v[204:207]
    s_waitcnt lgkmcnt(3)
    v_exp_f32 v184, v184
    v_mfma_f32_16x16x32_bf16 v[204:207], a[136:139], v[220:223], v[204:207]
    s_waitcnt lgkmcnt(2)
    v_cvt_pk_bf16_f32 v181, v182, v183
    v_exp_f32 v185, v185
    v_mfma_f32_16x16x32_bf16 v[204:207], a[140:143], v[224:227], v[204:207]
    v_exp_f32 v186, v186
    v_mfma_f32_16x16x32_bf16 v[200:203], a[108:111], v[236:239], v[200:203]
    v_cvt_pk_bf16_f32 v182, v184, v185
    v_exp_f32 v187, v187
    v_mfma_f32_16x16x32_bf16 v[200:203], a[112:115], v[220:223], v[200:203]
    s_add_u32 m0, s79, 22464
    s_add_u32 s18, s91, 516096
    buffer_load_dwordx4 v16, s[20:23], s18 offen nt lds
    v_mfma_f32_16x16x32_bf16 v[200:203], a[116:119], v[224:227], v[200:203]
    v_exp_f32 v188, v188
    v_mfma_f32_16x16x32_bf16 v[196:199], a[84:87], v[236:239], v[196:199]
    ds_read_b128 v[236:239], v7 offset:39680
    v_cvt_pk_bf16_f32 v183, v186, v187
    v_mfma_f32_16x16x32_bf16 v[196:199], a[88:91], v[220:223], v[196:199]
    ds_read_b128 v[220:223], v7 offset:40704
    v_exp_f32 v189, v189
    v_mfma_f32_16x16x32_bf16 v[208:211], v[128:131], v[180:183], 0
    v_exp_f32 v190, v190
    v_mfma_f32_16x16x32_bf16 v[212:215], v[136:139], v[180:183], 0
    v_cvt_pk_bf16_f32 v184, v188, v189
    v_exp_f32 v191, v191
    v_mfma_f32_16x16x32_bf16 v[216:219], v[144:147], v[180:183], 0
    v_exp_f32 v192, v192
    v_mfma_f32_16x16x32_bf16 v[196:199], a[92:95], v[224:227], v[196:199]
    ds_read_b128 v[224:227], v7 offset:41728
    v_cvt_pk_bf16_f32 v185, v190, v191
    v_mfma_f32_16x16x32_bf16 v[188:191], a[252:255], v[180:183], 0
    v_mov_b32 v187, 0
    v_cvt_pk_bf16_f32 v186, v192, 0
    v_cvt_pk_bf16_f32 v160, v200, v201
    v_cvt_pk_bf16_f32 v161, v202, v203
    v_mfma_f32_16x16x32_bf16 v[188:191], a[252:255], v[184:187], v[188:191]
    v_cvt_pk_bf16_f32 v158, v196, v197
    v_cvt_pk_bf16_f32 v159, v198, v199
    v_mfma_f32_16x16x32_bf16 v[208:211], v[132:135], v[184:187], v[208:211]
    v_cvt_pk_bf16_f32 v162, v204, v205
    v_cvt_pk_bf16_f32 v163, v206, v207
    v_mfma_f32_16x16x32_bf16 v[212:215], v[140:143], v[184:187], v[212:215]
    v_max3_f32 v252, v164, v165, v166
    v_max3_f32 v253, v167, v168, v169
    v_mfma_f32_16x16x32_bf16 v[216:219], v[148:151], v[184:187], v[216:219]
    v_rcp_f32 v188, v188
    v_mfma_f32_16x16x32_bf16 v[180:183], v[104:107], v[158:161], 0
    v_mul_f32 v208, v188, v208
    v_mul_f32 v209, v188, v209
    v_mfma_f32_16x16x32_bf16 v[184:187], v[110:113], v[158:161], 0
    s_add_u32 m0, s79, 26208
    s_add_u32 s18, s91, 602112
    buffer_load_dwordx4 v16, s[20:23], s18 offen nt lds
    v_mfma_f32_16x16x32_bf16 v[192:195], v[122:125], v[158:161], v[0:3]
    v_cvt_pk_bf16_f32 v208, v208, v209
    v_mul_f32 v210, v188, v210
    v_mfma_f32_16x16x16_bf16 v[180:183], v[108:109], v[162:163], v[180:183]
    v_mul_f32 v211, v188, v211
    v_cvt_pk_bf16_f32 v209, v210, v211
    v_mfma_f32_16x16x16_bf16 v[184:187], v[114:115], v[162:163], v[184:187]
    v_mul_f32 v212, v188, v212
    v_mul_f32 v213, v188, v213
    v_mfma_f32_16x16x16_bf16 v[192:195], v[126:127], v[162:163], v[192:195]
    s_waitcnt lgkmcnt(4)
    v_cvt_pk_bf16_f32 v210, v212, v213
    v_mul_f32 v214, v188, v214
    v_mfma_f32_16x16x32_bf16 v[196:199], a[0:3], v[228:231], 0
    s_waitcnt lgkmcnt(3)
    v_mul_f32 v215, v188, v215
    v_cvt_pk_bf16_f32 v211, v214, v215
    v_mfma_f32_16x16x32_bf16 v[196:199], a[4:7], v[232:235], v[196:199]
    s_waitcnt lgkmcnt(2)
    ds_write_b128 v8, v[208:211] offset:19200
    v_mfma_f32_16x16x32_bf16 v[196:199], a[8:11], v[236:239], v[196:199]
    v_mul_f32 v216, v188, v216
    v_mul_f32 v217, v188, v217
    v_mfma_f32_16x16x32_bf16 v[200:203], a[24:27], v[228:231], 0
    v_cvt_pk_bf16_f32 v212, v216, v217
    v_mul_f32 v218, v188, v218
    v_mfma_f32_16x16x32_bf16 v[200:203], a[28:31], v[232:235], v[200:203]
    v_mul_f32 v219, v188, v219
    v_cvt_pk_bf16_f32 v213, v218, v219
    v_mfma_f32_16x16x32_bf16 v[188:191], v[116:119], v[158:161], 0
    ds_read_b64_tr_b16 v[158:159], v18 offset:32
    ds_read_b64_tr_b16 v[160:161], v18 offset:1568
    v_mfma_f32_16x16x32_bf16 v[200:203], a[32:35], v[236:239], v[200:203]
    ds_write_b64 v9, v[212:213] offset:19200
    v_mfma_f32_16x16x32_bf16 v[204:207], a[48:51], v[228:231], 0
    ds_read_b128 v[228:231], v7 offset:42752
    v_max3_f32 v252, v252, v170, v171
    v_mfma_f32_16x16x16_bf16 v[188:191], v[120:121], v[162:163], v[188:191]
    v_max3_f32 v253, v253, v172, v173
    s_add_u32 m0, s79, 29952
    s_add_u32 s18, s91, 688128
    buffer_load_dwordx4 v16, s[28:31], s18 offen nt lds
    v_mfma_f32_16x16x32_bf16 v[204:207], a[52:55], v[232:235], v[204:207]
    ds_read_b128 v[232:235], v7 offset:43776
    v_max3_f32 v252, v252, v174, v175
    v_mfma_f32_16x16x32_bf16 v[204:207], a[56:59], v[236:239], v[204:207]
    s_waitcnt lgkmcnt(7)
    ds_read_b128 v[236:239], v7 offset:44800
    v_max3_f32 v252, v252, v253, v176
    v_mfma_f32_16x16x32_bf16 v[204:207], a[60:63], v[220:223], v[204:207]
    s_waitcnt lgkmcnt(7)
    v_mov_b32 v253, v252
    v_max3_f32 v254, v180, v181, v182
    v_mfma_f32_16x16x32_bf16 v[204:207], a[64:67], v[224:227], v[204:207]
    s_waitcnt lgkmcnt(2)
    v_permlane16_swap_b32 v252, v253
    v_mfma_f32_16x16x32_bf16 v[204:207], a[68:71], v[228:231], v[204:207]
    v_max_f32 v252, v252, v253
    v_mov_b32 v253, v252
    v_mfma_f32_16x16x32_bf16 v[200:203], a[36:39], v[220:223], v[200:203]
    s_nop 0
    v_permlane32_swap_b32 v252, v253
    v_mfma_f32_16x16x32_bf16 v[200:203], a[40:43], v[224:227], v[200:203]
    v_max_f32 v252, v252, v253
    v_mul_f32 v252, s54, v252
    v_mfma_f32_16x16x32_bf16 v[200:203], a[44:47], v[228:231], v[200:203]
    v_fma_f32 v164, v164, s54, -v252
    v_fma_f32 v165, v165, s54, -v252
    v_mfma_f32_16x16x32_bf16 v[196:199], a[12:15], v[220:223], v[196:199]
    ds_read_b128 v[220:223], v7 offset:45824
    v_fma_f32 v166, v166, s54, -v252
    v_mfma_f32_16x16x32_bf16 v[196:199], a[16:19], v[224:227], v[196:199]
    ds_read_b128 v[224:227], v7 offset:46848
    v_fma_f32 v167, v167, s54, -v252
    v_mfma_f32_16x16x32_bf16 v[196:199], a[20:23], v[228:231], v[196:199]
    ds_read_b128 v[228:231], v7 offset:47872
    v_fma_f32 v168, v168, s54, -v252
    v_fma_f32 v169, v169, s54, -v252
    v_fma_f32 v170, v170, s54, -v252
    v_fma_f32 v171, v171, s54, -v252
    v_fma_f32 v172, v172, s54, -v252
    v_fma_f32 v173, v173, s54, -v252
    v_fma_f32 v174, v174, s54, -v252
    v_fma_f32 v175, v175, s54, -v252
    v_fma_f32 v176, v176, s54, -v252
    v_exp_f32 v164, v164
    v_exp_f32 v165, v165
    v_exp_f32 v166, v166
    v_cvt_pk_bf16_f32 v164, v164, v165
    v_exp_f32 v167, v167
    v_exp_f32 v168, v168
    v_cvt_pk_bf16_f32 v165, v166, v167
    v_exp_f32 v169, v169
    v_exp_f32 v170, v170
    v_cvt_pk_bf16_f32 v166, v168, v169
    v_exp_f32 v171, v171
    v_exp_f32 v172, v172
    v_cvt_pk_bf16_f32 v167, v170, v171
    v_exp_f32 v173, v173
    v_exp_f32 v174, v174
    v_mfma_f32_16x16x32_bf16 v[208:211], v[128:131], v[164:167], 0
    v_cvt_pk_bf16_f32 v168, v172, v173
    v_exp_f32 v175, v175
    v_mfma_f32_16x16x32_bf16 v[212:215], v[136:139], v[164:167], 0
    v_exp_f32 v176, v176
    v_mfma_f32_16x16x32_bf16 v[216:219], v[144:147], v[164:167], 0
    v_cvt_pk_bf16_f32 v169, v174, v175
    v_mov_b32 v171, 0
    v_mfma_f32_16x16x32_bf16 v[172:175], a[252:255], v[164:167], 0
    v_cvt_pk_bf16_f32 v170, v176, 0
    v_cvt_pk_bf16_f32 v104, v196, v197
    v_cvt_pk_bf16_f32 v105, v198, v199
    v_mfma_f32_16x16x32_bf16 v[172:175], a[252:255], v[168:171], v[172:175]
    v_cvt_pk_bf16_f32 v106, v200, v201
    v_cvt_pk_bf16_f32 v107, v202, v203
    v_mfma_f32_16x16x32_bf16 v[208:211], v[132:135], v[168:171], v[208:211]
    v_cvt_pk_bf16_f32 v108, v204, v205
    v_cvt_pk_bf16_f32 v109, v206, v207
    v_mfma_f32_16x16x32_bf16 v[212:215], v[140:143], v[168:171], v[212:215]
    v_max3_f32 v255, v183, v184, v185
    v_max3_f32 v254, v254, v186, v187
    v_mfma_f32_16x16x32_bf16 v[216:219], v[148:151], v[168:171], v[216:219]
    v_rcp_f32 v172, v172
    v_mfma_f32_16x16x32_bf16 v[164:167], v[104:107], v[152:155], 0
    v_mul_f32 v208, v172, v208
    v_mul_f32 v209, v172, v209
    v_cvt_pk_bf16_f32 v208, v208, v209
    v_mul_f32 v210, v172, v210
    v_mul_f32 v211, v172, v211
    v_cvt_pk_bf16_f32 v209, v210, v211
    v_mfma_f32_16x16x16_bf16 v[164:167], v[108:109], v[156:157], v[164:167]
    s_waitcnt lgkmcnt(4)
    v_mul_f32 v212, v172, v212
    v_mul_f32 v213, v172, v213
    v_cvt_pk_bf16_f32 v210, v212, v213
    v_mul_f32 v214, v172, v214
    v_mul_f32 v215, v172, v215
    v_cvt_pk_bf16_f32 v211, v214, v215
    v_mul_f32 v216, v172, v216
    v_mul_f32 v217, v172, v217
    v_cvt_pk_bf16_f32 v212, v216, v217
    v_mul_f32 v218, v172, v218
    v_mul_f32 v219, v172, v219
    v_cvt_pk_bf16_f32 v213, v218, v219
    v_mfma_f32_16x16x32_bf16 v[216:219], a[48:51], v[232:235], 0
    ds_write_b128 v8, v[208:211] offset:25344
    v_mfma_f32_16x16x32_bf16 v[208:211], a[0:3], v[232:235], 0
    s_waitcnt lgkmcnt(4)
    v_max3_f32 v255, v255, v188, v189
    v_max3_f32 v254, v254, v190, v191
    v_mfma_f32_16x16x32_bf16 v[208:211], a[4:7], v[236:239], v[208:211]
    s_waitcnt lgkmcnt(3)
    v_max3_f32 v254, v254, v255, v192
    v_mov_b32 v255, v254
    v_mfma_f32_16x16x32_bf16 v[208:211], a[8:11], v[220:223], v[208:211]
    s_nop 0
    v_permlane16_swap_b32 v254, v255
    v_mfma_f32_16x16x32_bf16 v[216:219], a[52:55], v[236:239], v[216:219]
    v_max_f32 v254, v254, v255
    v_mov_b32 v255, v254
    v_mfma_f32_16x16x32_bf16 v[216:219], a[56:59], v[220:223], v[216:219]
    ds_write_b64 v9, v[212:213] offset:25344
    v_mfma_f32_16x16x32_bf16 v[212:215], a[24:27], v[232:235], 0
    ds_read_b128 v[232:235], v7 offset:48896
    v_permlane32_swap_b32 v254, v255
    v_mfma_f32_16x16x32_bf16 v[212:215], a[28:31], v[236:239], v[212:215]
    ds_read_b128 v[236:239], v7 offset:49920
    v_max_f32 v254, v254, v255
    v_mfma_f32_16x16x32_bf16 v[212:215], a[32:35], v[220:223], v[212:215]
    s_waitcnt lgkmcnt(5)
    ds_read_b128 v[220:223], v7 offset:50944
    v_mul_f32 v254, s54, v254
    v_mfma_f32_16x16x32_bf16 v[216:219], a[60:63], v[224:227], v[216:219]
    s_waitcnt lgkmcnt(5)
    v_fma_f32 v180, v180, s54, -v254
    v_fma_f32 v181, v181, s54, -v254
    v_mfma_f32_16x16x32_bf16 v[216:219], a[64:67], v[228:231], v[216:219]
    v_fma_f32 v182, v182, s54, -v254
    v_fma_f32 v183, v183, s54, -v254
    v_mfma_f32_16x16x32_bf16 v[212:215], a[36:39], v[224:227], v[212:215]
    v_fma_f32 v184, v184, s54, -v254
    v_fma_f32 v185, v185, s54, -v254
    v_mfma_f32_16x16x32_bf16 v[212:215], a[40:43], v[228:231], v[212:215]
    s_waitcnt lgkmcnt(2)
    v_fma_f32 v186, v186, s54, -v254
    v_fma_f32 v187, v187, s54, -v254
    v_mfma_f32_16x16x32_bf16 v[216:219], a[68:71], v[232:235], v[216:219]
    v_fma_f32 v188, v188, s54, -v254
    v_fma_f32 v189, v189, s54, -v254
    v_mfma_f32_16x16x32_bf16 v[212:215], a[44:47], v[232:235], v[212:215]
    v_fma_f32 v190, v190, s54, -v254
    v_fma_f32 v191, v191, s54, -v254
    v_mfma_f32_16x16x32_bf16 v[208:211], a[12:15], v[224:227], v[208:211]
    ds_read_b128 v[224:227], v7 offset:51968
    v_fma_f32 v192, v192, s54, -v254
    v_mfma_f32_16x16x32_bf16 v[208:211], a[16:19], v[228:231], v[208:211]
    ds_read_b128 v[228:231], v7 offset:52992
    v_exp_f32 v180, v180
    v_mfma_f32_16x16x32_bf16 v[208:211], a[20:23], v[232:235], v[208:211]
    ds_read_b128 v[232:235], v7 offset:54016
    v_exp_f32 v181, v181
    v_exp_f32 v182, v182
    v_cvt_pk_bf16_f32 v180, v180, v181
    v_exp_f32 v183, v183
    v_exp_f32 v184, v184
    v_cvt_pk_bf16_f32 v181, v182, v183
    v_exp_f32 v185, v185
    v_exp_f32 v186, v186
    v_cvt_pk_bf16_f32 v182, v184, v185
    v_exp_f32 v187, v187
    v_exp_f32 v188, v188
    v_cvt_pk_bf16_f32 v183, v186, v187
    v_exp_f32 v189, v189
    v_exp_f32 v190, v190
    v_mfma_f32_16x16x32_bf16 v[196:199], v[128:131], v[180:183], 0
    ds_read_b64_tr_b16 v[128:129], v18 offset:64
    ds_read_b64_tr_b16 v[130:131], v18 offset:1600
    v_mfma_f32_16x16x32_bf16 v[200:203], v[136:139], v[180:183], 0
    ds_read_b64_tr_b16 v[136:137], v18 offset:4608
    ds_read_b64_tr_b16 v[138:139], v18 offset:6144
    v_mfma_f32_16x16x32_bf16 v[204:207], v[144:147], v[180:183], 0
    ds_read_b64_tr_b16 v[144:145], v18 offset:0
    ds_read_b64_tr_b16 v[146:147], v18 offset:1536
    v_cvt_pk_bf16_f32 v184, v188, v189
    v_exp_f32 v191, v191
    v_exp_f32 v192, v192
    v_cvt_pk_bf16_f32 v185, v190, v191
    v_mfma_f32_16x16x32_bf16 v[188:191], a[252:255], v[180:183], 0
    v_mov_b32 v187, 0
    v_cvt_pk_bf16_f32 v186, v192, 0
    v_cvt_pk_bf16_f32 v110, v208, v209
    v_cvt_pk_bf16_f32 v111, v210, v211
    v_mfma_f32_16x16x32_bf16 v[188:191], a[252:255], v[184:187], v[188:191]
    v_cvt_pk_bf16_f32 v112, v212, v213
    v_cvt_pk_bf16_f32 v113, v214, v215
    v_mfma_f32_16x16x32_bf16 v[196:199], v[132:135], v[184:187], v[196:199]
    v_cvt_pk_bf16_f32 v114, v216, v217
    v_cvt_pk_bf16_f32 v115, v218, v219
    v_mfma_f32_16x16x32_bf16 v[200:203], v[140:143], v[184:187], v[200:203]
    v_mov_b32 v0, 0xff800000
    v_cndmask_b32_e64 v0, v0, 0, vcc
    v_mfma_f32_16x16x32_bf16 v[204:207], v[148:151], v[184:187], v[204:207]
    s_mov_b64 vcc, 0
    v_rcp_f32 v188, v188
    s_waitcnt lgkmcnt(10)
    v_mfma_f32_16x16x32_bf16 v[208:211], a[0:3], v[236:239], 0
    s_mov_b32 vcc_hi, 0xffff0000
    v_mul_f32 v196, v188, v196
    v_mul_f32 v197, v188, v197
    s_waitcnt lgkmcnt(9)
    v_mfma_f32_16x16x32_bf16 v[208:211], a[4:7], v[220:223], v[208:211]
    s_waitcnt lgkmcnt(8)
    v_cvt_pk_bf16_f32 v196, v196, v197
    v_mul_f32 v198, v188, v198
    v_mfma_f32_16x16x32_bf16 v[208:211], a[8:11], v[224:227], v[208:211]
    v_mul_f32 v199, v188, v199
    v_cvt_pk_bf16_f32 v197, v198, v199
    v_mfma_f32_16x16x32_bf16 v[212:215], a[24:27], v[236:239], 0
    v_mul_f32 v200, v188, v200
    v_mul_f32 v201, v188, v201
    v_mfma_f32_16x16x32_bf16 v[212:215], a[28:31], v[220:223], v[212:215]
    v_cvt_pk_bf16_f32 v198, v200, v201
    v_mul_f32 v202, v188, v202
    v_mfma_f32_16x16x32_bf16 v[212:215], a[32:35], v[224:227], v[212:215]
    v_mul_f32 v203, v188, v203
    v_cvt_pk_bf16_f32 v199, v202, v203
    v_mfma_f32_16x16x32_bf16 v[216:219], a[48:51], v[236:239], 0
    ds_write_b128 v8, v[196:199] offset:31488
    v_mfma_f32_16x16x32_bf16 v[216:219], a[52:55], v[220:223], v[216:219]
    ds_read_b128 v[236:239], v7 offset:55040
    v_mul_f32 v204, v188, v204
    v_mfma_f32_16x16x32_bf16 v[216:219], a[56:59], v[224:227], v[216:219]
    s_waitcnt lgkmcnt(9)
    ds_read_b128 v[196:199], v17 offset:0
    v_mul_f32 v205, v188, v205
    v_mfma_f32_16x16x32_bf16 v[216:219], a[60:63], v[228:231], v[216:219]
    s_waitcnt lgkmcnt(9)
    v_cvt_pk_bf16_f32 v200, v204, v205
    v_mul_f32 v206, v188, v206
    v_mfma_f32_16x16x32_bf16 v[216:219], a[64:67], v[232:235], v[216:219]
    v_mul_f32 v207, v188, v207
    v_cvt_pk_bf16_f32 v201, v206, v207
    v_mfma_f32_16x16x32_bf16 v[212:215], a[36:39], v[228:231], v[212:215]
    ds_write_b64 v9, v[200:201] offset:31488
    v_mfma_f32_16x16x32_bf16 v[212:215], a[40:43], v[232:235], v[212:215]
    ds_read_b128 v[200:203], v17 offset:1024
    ds_read_b128 v[204:207], v17 offset:2048
    v_mfma_f32_16x16x32_bf16 v[208:211], a[12:15], v[228:231], v[208:211]
    s_waitcnt lgkmcnt(4)
    v_max3_f32 v252, v164, v165, v166
    v_lshl_add_u32 v248, v7, 1, s19
    v_mfma_f32_16x16x32_bf16 v[216:219], a[68:71], v[236:239], v[216:219]
    v_mfma_f32_16x16x32_bf16 v[212:215], a[44:47], v[236:239], v[212:215]
    v_mfma_f32_16x16x32_bf16 v[208:211], a[16:19], v[232:235], v[208:211]
    v_mfma_f32_16x16x32_bf16 v[208:211], a[20:23], v[236:239], v[208:211]
    s_waitcnt vmcnt(0) lgkmcnt(2)
    s_barrier
    v_mfma_f32_16x16x32_bf16 v[168:171], v[110:113], v[152:155], 0
    ds_read_b128 v[180:183], v7 offset:21248
    v_mfma_f32_16x16x32_bf16 v[176:179], v[122:125], v[152:155], v[0:3]
    ds_read_b128 v[184:187], v7 offset:27392
    v_cvt_pk_bf16_f32 v118, v212, v213
    v_cvt_pk_bf16_f32 v119, v214, v215
    v_cvt_pk_bf16_f32 v116, v208, v209
    v_mfma_f32_16x16x16_bf16 v[168:171], v[114:115], v[156:157], v[168:171]
    ds_read_b128 v[188:191], v7 offset:33536
    v_cvt_pk_bf16_f32 v117, v210, v211
    v_mfma_f32_16x16x16_bf16 v[176:179], v[126:127], v[156:157], v[176:179]
    ds_read_b128 v[192:195], v7 offset:22272
    v_cvt_pk_bf16_f32 v120, v216, v217
    v_mfma_f32_16x16x32_bf16 v[172:175], v[116:119], v[152:155], 0
    ds_read_b128 v[220:223], v7 offset:28416
    v_cvt_pk_bf16_f32 v121, v218, v219
    v_max3_f32 v253, v167, v168, v169
    v_max3_f32 v252, v252, v170, v171
    s_nop 1
    v_mfma_f32_16x16x16_bf16 v[172:175], v[120:121], v[156:157], v[172:175]
    s_waitcnt lgkmcnt(4)
    ds_read_b128 v[224:227], v7 offset:34560
    v_mfma_f32_16x16x32_bf16 v[68:71], v[144:147], v[180:183], v[68:71]
    s_waitcnt lgkmcnt(4)
    ds_read_b128 v[228:231], v7 offset:23296
    v_mfma_f32_16x16x32_bf16 v[80:83], v[144:147], v[184:187], v[80:83]
    s_waitcnt lgkmcnt(4)
    ds_read_b128 v[232:235], v7 offset:25344
    v_mfma_f32_16x16x32_bf16 v[92:95], v[144:147], v[188:191], v[92:95]
    ds_read_b64_tr_b16 v[144:145], v18 offset:4640
    ds_read_b64_tr_b16 v[146:147], v18 offset:6176
    v_mfma_f32_16x16x32_bf16 v[72:75], v[158:161], v[180:183], v[72:75]
    ds_read_b128 v[236:239], v7 offset:26368
    v_max3_f32 v253, v253, v172, v173
    v_mfma_f32_16x16x32_bf16 v[84:87], v[158:161], v[184:187], v[84:87]
    ds_read_b128 v[208:211], v17 offset:3072
    v_max3_f32 v252, v252, v174, v175
    v_mfma_f32_16x16x32_bf16 v[96:99], v[158:161], v[188:191], v[96:99]
    ds_read_b64_tr_b16 v[158:159], v18 offset:4672
    ds_read_b64_tr_b16 v[160:161], v18 offset:6208
    v_mfma_f32_16x16x32_bf16 v[76:79], v[128:131], v[180:183], v[76:79]
    ds_read_b128 v[180:183], v7 offset:24320
    v_max3_f32 v252, v252, v253, v176
    v_mfma_f32_16x16x32_bf16 v[88:91], v[128:131], v[184:187], v[88:91]
    ds_read_b128 v[184:187], v7 offset:30464
    v_mov_b32 v253, v252
    v_mfma_f32_16x16x32_bf16 v[100:103], v[128:131], v[188:191], v[100:103]
    s_waitcnt lgkmcnt(12)
    ds_read_b64_tr_b16 v[128:129], v18 offset:3072
    ds_read_b64_tr_b16 v[130:131], v18 offset:7680
    v_mfma_f32_16x16x32_bf16 v[68:71], v[136:139], v[192:195], v[68:71]
    s_waitcnt lgkmcnt(13)
    ds_read_b128 v[188:191], v7 offset:36608
    v_permlane16_swap_b32 v252, v253
    v_mfma_f32_16x16x32_bf16 v[80:83], v[136:139], v[220:223], v[80:83]
    s_waitcnt lgkmcnt(13)
    ds_read_b128 v[212:215], v17 offset:4096
    v_max_f32 v252, v252, v253
    v_mfma_f32_16x16x32_bf16 v[92:95], v[136:139], v[224:227], v[92:95]
    s_waitcnt lgkmcnt(10)
    ds_read_b64_tr_b16 v[136:137], v18 offset:3104
    ds_read_b64_tr_b16 v[138:139], v18 offset:7712
    v_mfma_f32_16x16x32_bf16 v[72:75], v[144:147], v[192:195], v[72:75]
    ds_read_b128 v[216:219], v17 offset:5120
    v_mov_b32 v253, v252
    v_mfma_f32_16x16x32_bf16 v[84:87], v[144:147], v[220:223], v[84:87]
    s_nop 0
    v_permlane32_swap_b32 v252, v253
    v_mfma_f32_16x16x32_bf16 v[96:99], v[144:147], v[224:227], v[96:99]
    s_waitcnt lgkmcnt(9)
    ds_read_b64_tr_b16 v[144:145], v18 offset:3136
    ds_read_b64_tr_b16 v[146:147], v18 offset:7744
    v_mfma_f32_16x16x32_bf16 v[76:79], v[158:161], v[192:195], v[76:79]
    ds_read_b128 v[192:195], v1 offset:4160
    v_max_f32 v252, v252, v253
    v_mfma_f32_16x16x32_bf16 v[88:91], v[158:161], v[220:223], v[88:91]
    ds_read_b128 v[220:223], v7 offset:19200
    v_mul_f32 v252, s54, v252
    v_mfma_f32_16x16x32_bf16 v[100:103], v[158:161], v[224:227], v[100:103]
    s_waitcnt lgkmcnt(9)
    ds_read_b128 v[224:227], v7 offset:20224
    s_andn2_b64 exec, -1, s[80:81]
    v_mov_b32 v252, 0x7f800000
    s_mov_b64 exec, -1
    v_mfma_f32_16x16x32_bf16 v[68:71], v[128:131], v[180:183], v[68:71]
    ds_read_b128 v[158:161], v4 offset:7488
    v_fma_f32 v164, v164, s54, -v252
    v_mfma_f32_16x16x32_bf16 v[80:83], v[128:131], v[184:187], v[80:83]
    s_waitcnt lgkmcnt(10)
    v_fma_f32 v165, v165, s54, -v252
    v_fma_f32 v166, v166, s54, -v252
    v_mfma_f32_16x16x32_bf16 v[92:95], v[128:131], v[188:191], v[92:95]
    s_waitcnt lgkmcnt(7)
    ds_read_b128 v[128:131], v4 offset:7520
    v_fma_f32 v167, v167, s54, -v252
    v_mfma_f32_16x16x32_bf16 v[72:75], v[136:139], v[180:183], v[72:75]
    v_fma_f32 v168, v168, s54, -v252
    v_fma_f32 v169, v169, s54, -v252
    v_mfma_f32_16x16x32_bf16 v[84:87], v[136:139], v[184:187], v[84:87]
    v_fma_f32 v170, v170, s54, -v252
    v_fma_f32 v171, v171, s54, -v252
    v_mfma_f32_16x16x32_bf16 v[96:99], v[136:139], v[188:191], v[96:99]
    s_waitcnt lgkmcnt(5)
    ds_read_b128 v[136:139], v4 offset:7552
    v_fma_f32 v172, v172, s54, -v252
    v_mfma_f32_16x16x32_bf16 v[76:79], v[144:147], v[180:183], v[76:79]
    ds_read_b128 v[180:183], v1 offset:0
    v_fma_f32 v173, v173, s54, -v252
    v_mfma_f32_16x16x32_bf16 v[88:91], v[144:147], v[184:187], v[88:91]
    ds_read_b128 v[184:187], v1 offset:416
    v_fma_f32 v174, v174, s54, -v252
    v_mfma_f32_16x16x32_bf16 v[100:103], v[144:147], v[188:191], v[100:103]
    s_waitcnt lgkmcnt(6)
    ds_read_b128 v[188:191], v1 offset:832
    v_fma_f32 v175, v175, s54, -v252
    v_mfma_f32_16x16x32_bf16 v[68:71], a[216:219], v[220:223], v[68:71]
    s_waitcnt lgkmcnt(6)
    ds_read_b128 v[144:147], v5 offset:7488
    v_fma_f32 v176, v176, s54, -v252
    v_mfma_f32_16x16x32_bf16 v[68:71], a[220:223], v[224:227], v[68:71]
    v_exp_f32 v164, v164
    v_mfma_f32_16x16x32_bf16 v[68:71], a[224:227], v[228:231], v[68:71]
    v_exp_f32 v165, v165
    v_mfma_f32_16x16x32_bf16 v[72:75], a[228:231], v[220:223], v[72:75]
    v_exp_f32 v166, v166
    v_mfma_f32_16x16x32_bf16 v[72:75], a[232:235], v[224:227], v[72:75]
    v_cvt_pk_bf16_f32 v164, v164, v165
    v_exp_f32 v167, v167
    v_mfma_f32_16x16x32_bf16 v[72:75], a[236:239], v[228:231], v[72:75]
    v_exp_f32 v168, v168
    v_mfma_f32_16x16x32_bf16 v[76:79], a[240:243], v[220:223], v[76:79]
    ds_read_b128 v[220:223], v7 offset:29440
    v_cvt_pk_bf16_f32 v165, v166, v167
    v_mfma_f32_16x16x32_bf16 v[76:79], a[244:247], v[224:227], v[76:79]
    ds_read_b128 v[224:227], v7 offset:31488
    v_exp_f32 v169, v169
    v_mfma_f32_16x16x32_bf16 v[76:79], a[248:251], v[228:231], v[76:79]
    ds_read_b128 v[228:231], v7 offset:32512
    v_exp_f32 v170, v170
    v_mfma_f32_16x16x32_bf16 v[80:83], a[216:219], v[232:235], v[80:83]
    v_cvt_pk_bf16_f32 v166, v168, v169
    v_exp_f32 v171, v171
    v_mfma_f32_16x16x32_bf16 v[80:83], a[220:223], v[236:239], v[80:83]
    v_exp_f32 v172, v172
    v_mfma_f32_16x16x32_bf16 v[84:87], a[228:231], v[232:235], v[84:87]
    s_waitcnt lgkmcnt(2)
    v_cvt_pk_bf16_f32 v167, v170, v171
    v_exp_f32 v173, v173
    v_mfma_f32_16x16x32_bf16 v[80:83], a[224:227], v[220:223], v[80:83]
    v_exp_f32 v174, v174
    v_mfma_f32_16x16x32_bf16 v[84:87], a[232:235], v[236:239], v[84:87]
    v_cvt_pk_bf16_f32 v168, v172, v173
    v_exp_f32 v175, v175
    v_mfma_f32_16x16x32_bf16 v[84:87], a[236:239], v[220:223], v[84:87]
    v_exp_f32 v176, v176
    v_mfma_f32_16x16x32_bf16 v[88:91], a[240:243], v[232:235], v[88:91]
    ds_read_b128 v[232:235], v7 offset:35584
    v_cvt_pk_bf16_f32 v169, v174, v175
    v_mfma_f32_16x16x32_bf16 v[88:91], a[244:247], v[236:239], v[88:91]
    ds_read_b128 v[172:175], v1 offset:32
    v_mov_b32 v171, 0
    v_mfma_f32_16x16x32_bf16 v[88:91], a[248:251], v[220:223], v[88:91]
    s_waitcnt lgkmcnt(3)
    ds_read_b128 v[236:239], v7 offset:37632
    v_cvt_pk_bf16_f32 v170, v176, 0
    v_mfma_f32_16x16x32_bf16 v[92:95], a[216:219], v[224:227], v[92:95]
    s_waitcnt lgkmcnt(3)
    ds_read_b128 v[176:179], v1 offset:448
    v_cvt_pk_bf16_f32 v68, v68, v69
    v_mfma_f32_16x16x32_bf16 v[92:95], a[220:223], v[228:231], v[92:95]
    ds_read_b128 v[220:223], v7 offset:38656
    v_cvt_pk_bf16_f32 v69, v70, v71
    v_mfma_f32_16x16x32_bf16 v[96:99], a[228:231], v[224:227], v[96:99]
    ds_write_b64 v12, v[68:69] offset:0
    v_mfma_f32_16x16x32_bf16 v[96:99], a[232:235], v[228:231], v[96:99]
    s_waitcnt lgkmcnt(5)
    v_cvt_pk_bf16_f32 v72, v72, v73
    v_cvt_pk_bf16_f32 v73, v74, v75
    v_mfma_f32_16x16x32_bf16 v[92:95], a[224:227], v[232:235], v[92:95]
    v_cvt_pk_bf16_f32 v76, v76, v77
    v_cvt_pk_bf16_f32 v77, v78, v79
    v_mfma_f32_16x16x32_bf16 v[96:99], a[236:239], v[232:235], v[96:99]
    v_cvt_pk_bf16_f32 v80, v80, v81
    v_cvt_pk_bf16_f32 v81, v82, v83
    v_mfma_f32_16x16x32_bf16 v[100:103], a[240:243], v[224:227], v[100:103]
    ds_read_b128 v[224:227], v7 offset:39680
    v_cvt_pk_bf16_f32 v84, v84, v85
    v_mfma_f32_16x16x32_bf16 v[100:103], a[244:247], v[228:231], v[100:103]
    ds_read_b128 v[228:231], v7 offset:40704
    v_cvt_pk_bf16_f32 v85, v86, v87
    v_mfma_f32_16x16x32_bf16 v[100:103], a[248:251], v[232:235], v[100:103]
    ds_write_b64 v12, v[72:73] offset:32
    v_mfma_f32_16x16x32_bf16 v[68:71], v[20:23], v[158:161], 0
    ds_read_b128 v[158:161], v5 offset:7520
    v_cvt_pk_bf16_f32 v88, v88, v89
    v_mfma_f32_16x16x32_bf16 v[72:75], v[24:27], v[128:131], 0
    ds_read_b128 v[128:131], v5 offset:7552
    v_cvt_pk_bf16_f32 v89, v90, v91
    v_cvt_pk_bf16_f32 v92, v92, v93
    v_smfmac_f32_16x16x64_bf16 v[68:71], v[196:199], v[180:187], v19
    ds_read_b128 v[180:183], v1 offset:864
    v_cvt_pk_bf16_f32 v93, v94, v95
    v_smfmac_f32_16x16x64_bf16 v[68:71], v[200:203], v[188:195], v19
    s_waitcnt lgkmcnt(8)
    ds_read_b128 v[184:187], v1 offset:4192
    v_cvt_pk_bf16_f32 v96, v96, v97
    v_smfmac_f32_16x16x64_bf16 v[72:75], v[204:207], v[172:179], v19
    ds_read_b128 v[188:191], v1 offset:64
    ds_write_b64 v12, v[76:77] offset:64
    v_mfma_f32_16x16x32_bf16 v[76:79], v[28:31], v[136:139], 0
    v_cvt_pk_bf16_f32 v97, v98, v99
    v_cvt_pk_bf16_f32 v100, v100, v101
    v_cvt_pk_bf16_f32 v101, v102, v103
    ds_read_b128 v[192:195], v1 offset:480
    ds_read_b128 v[172:175], v1 offset:896
    v_add_f32 v240, v68, v69
    v_mul_f32 v241, v68, v68
    v_fmac_f32 v241, v69, v69
    v_add_f32 v240, v240, v70
    v_fmac_f32 v241, v70, v70
    s_waitcnt lgkmcnt(4)
    v_smfmac_f32_16x16x64_bf16 v[72:75], v[208:211], v[180:187], v19
    ds_read_b128 v[176:179], v1 offset:4224
    ds_write_b64 v12, v[80:81] offset:6400
    v_mfma_f32_16x16x32_bf16 v[80:83], v[20:23], v[144:147], 0
    v_add_f32 v240, v240, v71
    v_fmac_f32 v241, v71, v71
    ds_read_b128 v[180:183], v2 offset:0
    s_waitcnt lgkmcnt(4)
    v_smfmac_f32_16x16x64_bf16 v[76:79], v[212:215], v[188:195], v19
    ds_read_b128 v[184:187], v2 offset:416
    v_add_f32 v240, v240, v72
    v_fmac_f32 v241, v72, v72
    v_add_f32 v240, v240, v73
    v_fmac_f32 v241, v73, v73
    v_add_f32 v240, v240, v74
    v_fmac_f32 v241, v74, v74
    v_add_f32 v240, v240, v75
    v_fmac_f32 v241, v75, v75
    s_waitcnt lgkmcnt(3)
    v_smfmac_f32_16x16x64_bf16 v[76:79], v[216:219], v[172:179], v19
    ds_write_b64 v12, v[84:85] offset:6432
    v_mfma_f32_16x16x32_bf16 v[84:87], v[24:27], v[158:161], 0
    ds_read_b128 v[188:191], v2 offset:832
    ds_read_b128 v[192:195], v2 offset:4160
    ds_read_b128 v[172:175], v2 offset:32
    s_waitcnt lgkmcnt(4)
    v_smfmac_f32_16x16x64_bf16 v[80:83], v[196:199], v[180:187], v19
    ds_read_b128 v[176:179], v2 offset:448
    v_add_f32 v240, v240, v76
    v_fmac_f32 v241, v76, v76
    v_add_f32 v240, v240, v77
    v_fmac_f32 v241, v77, v77
    v_add_f32 v240, v240, v78
    ds_write_b64 v12, v[88:89] offset:6464
    v_mfma_f32_16x16x32_bf16 v[88:91], v[28:31], v[128:131], 0
    ds_read_b128 v[180:183], v2 offset:864
    v_fmac_f32 v241, v78, v78
    v_add_f32 v240, v240, v79
    v_fmac_f32 v241, v79, v79
    s_waitcnt lgkmcnt(4)
    v_smfmac_f32_16x16x64_bf16 v[80:83], v[200:203], v[188:195], v19
    ds_read_b128 v[184:187], v2 offset:4192
    v_permlane16_swap_b32 v240, v241
    v_add_f32 v240, v240, v241
    s_waitcnt lgkmcnt(3)
    v_smfmac_f32_16x16x64_bf16 v[84:87], v[204:207], v[172:179], v19
    ds_read_b128 v[188:191], v2 offset:64
    ds_read_b128 v[192:195], v2 offset:480
    ds_write_b64 v12, v[92:93] offset:12800
    v_add_f32 v242, v80, v81
    ds_read_b128 v[172:175], v2 offset:896
    v_mul_f32 v243, v80, v80
    v_fmac_f32 v243, v81, v81
    v_add_f32 v242, v242, v82
    s_waitcnt lgkmcnt(4)
    v_smfmac_f32_16x16x64_bf16 v[84:87], v[208:211], v[180:187], v19
    ds_read_b128 v[176:179], v2 offset:4224
    v_fmac_f32 v243, v82, v82
    v_add_f32 v242, v242, v83
    v_fmac_f32 v243, v83, v83
    ds_read_b128 v[136:139], v6 offset:7488
    ds_read_b128 v[180:183], v3 offset:0
    s_waitcnt lgkmcnt(5)
    v_smfmac_f32_16x16x64_bf16 v[88:91], v[212:215], v[188:195], v19
    ds_write_b64 v12, v[96:97] offset:12832
    v_add_f32 v242, v242, v84
    v_fmac_f32 v243, v84, v84
    v_add_f32 v242, v242, v85
    v_fmac_f32 v243, v85, v85
    v_add_f32 v242, v242, v86
    v_fmac_f32 v243, v86, v86
    v_add_f32 v242, v242, v87
    v_fmac_f32 v243, v87, v87
    s_waitcnt lgkmcnt(3)
    v_smfmac_f32_16x16x64_bf16 v[88:91], v[216:219], v[172:179], v19
    s_waitcnt lgkmcnt(2)
    ds_read_b128 v[184:187], v3 offset:416
    ds_read_b128 v[188:191], v3 offset:832
    v_mfma_f32_16x16x32_bf16 v[92:95], v[20:23], v[136:139], 0
    ds_read_b128 v[192:195], v3 offset:4160
    ds_write_b64 v12, v[100:101] offset:12864
    s_nop 1
    v_add_f32 v242, v242, v88
    v_fmac_f32 v243, v88, v88
    v_add_f32 v242, v242, v89
    v_fmac_f32 v243, v89, v89
    v_add_f32 v242, v242, v90
    v_fmac_f32 v243, v90, v90
    v_add_f32 v242, v242, v91
    v_fmac_f32 v243, v91, v91
    s_waitcnt lgkmcnt(3)
    v_smfmac_f32_16x16x64_bf16 v[92:95], v[196:199], v[180:187], v19
    ds_read_b128 v[144:147], v6 offset:7520
    v_permlane16_swap_b32 v242, v243
    v_mfma_f32_16x16x32_bf16 v[196:199], v[236:239], a[144:147], 0
    s_waitcnt lgkmcnt(2)
    ds_read_b128 v[172:175], v3 offset:32
    v_add_f32 v242, v242, v243
    v_smfmac_f32_16x16x64_bf16 v[92:95], v[200:203], v[188:195], v19
    ds_read_b128 v[176:179], v3 offset:448
    v_permlane32_swap_b32 v240, v242
    v_mfma_f32_16x16x32_bf16 v[196:199], v[220:223], a[148:151], v[196:199]
    ds_read_b128 v[180:183], v3 offset:864
    v_add_f32 v240, v240, v242
    v_mfma_f32_16x16x32_bf16 v[196:199], v[224:227], a[152:155], v[196:199]
    ds_write_b32 v10, v240 offset:0
    v_mfma_f32_16x16x32_bf16 v[200:203], v[236:239], a[168:171], 0
    s_waitcnt lgkmcnt(4)
    ds_read_b128 v[184:187], v3 offset:4192
    v_add_f32 v244, v92, v93
    v_mfma_f32_16x16x32_bf16 v[96:99], v[24:27], v[144:147], 0
    ds_read_b128 v[158:161], v6 offset:7552
    v_mul_f32 v245, v92, v92
    v_mfma_f32_16x16x32_bf16 v[200:203], v[220:223], a[172:175], v[200:203]
    ds_read_b128 v[188:191], v3 offset:64
    v_fmac_f32 v245, v93, v93
    v_mfma_f32_16x16x32_bf16 v[200:203], v[224:227], a[176:179], v[200:203]
    s_waitcnt lgkmcnt(5)
    ds_read_b128 v[192:195], v3 offset:480
    v_add_f32 v244, v244, v94
    v_smfmac_f32_16x16x64_bf16 v[96:99], v[204:207], v[172:179], v19
    ds_read_b128 v[172:175], v3 offset:896
    v_fmac_f32 v245, v94, v94
    v_mfma_f32_16x16x32_bf16 v[204:207], v[236:239], a[192:195], 0
    ds_read_b128 v[176:179], v3 offset:4224
    v_add_f32 v244, v244, v95
    v_mfma_f32_16x16x32_bf16 v[204:207], v[220:223], a[196:199], v[204:207]
    s_waitcnt lgkmcnt(5)
    ds_read_b128 v[232:235], v7 offset:41728
    v_fmac_f32 v245, v95, v95
    v_smfmac_f32_16x16x64_bf16 v[96:99], v[208:211], v[180:187], v19
    s_waitcnt lgkmcnt(5)
    ds_read_b128 v[236:239], v7 offset:42752
    v_mfma_f32_16x16x32_bf16 v[100:103], v[28:31], v[158:161], 0
    ds_read_b128 v[220:223], v7 offset:43776
    v_mfma_f32_16x16x32_bf16 v[204:207], v[224:227], a[200:203], v[204:207]
    ds_read_b128 v[224:227], v7 offset:44800
    v_mfma_f32_16x16x32_bf16 v[204:207], v[228:231], a[204:207], v[204:207]
    s_nop 0
    v_add_f32 v244, v244, v96
    v_fmac_f32 v245, v96, v96
    s_waitcnt lgkmcnt(6)
    v_smfmac_f32_16x16x64_bf16 v[100:103], v[212:215], v[188:195], v19
    s_waitcnt lgkmcnt(4)
    v_add_f32 v244, v244, v97
    v_fmac_f32 v245, v97, v97
    v_smfmac_f32_16x16x64_bf16 v[100:103], v[216:219], v[172:179], v19
    s_waitcnt lgkmcnt(3)
    v_add_f32 v244, v244, v98
    v_fmac_f32 v245, v98, v98
    v_mfma_f32_16x16x32_bf16 v[204:207], v[232:235], a[208:211], v[204:207]
    s_waitcnt lgkmcnt(2)
    v_add_f32 v244, v244, v99
    v_fmac_f32 v245, v99, v99
    v_mfma_f32_16x16x32_bf16 v[204:207], v[236:239], a[212:215], v[204:207]
    v_add_f32 v244, v244, v100
    v_fmac_f32 v245, v100, v100
    v_mfma_f32_16x16x32_bf16 v[200:203], v[228:231], a[180:183], v[200:203]
    v_add_f32 v244, v244, v101
    v_fmac_f32 v245, v101, v101
    v_mfma_f32_16x16x32_bf16 v[200:203], v[232:235], a[184:187], v[200:203]
    v_add_f32 v244, v244, v102
    v_fmac_f32 v245, v102, v102
    v_mfma_f32_16x16x32_bf16 v[200:203], v[236:239], a[188:191], v[200:203]
    v_add_f32 v244, v244, v103
    v_fmac_f32 v245, v103, v103
    v_mfma_f32_16x16x32_bf16 v[196:199], v[228:231], a[156:159], v[196:199]
    ds_read_b128 v[228:231], v7 offset:45824
    v_permlane16_swap_b32 v244, v245
    v_mfma_f32_16x16x32_bf16 v[196:199], v[232:235], a[160:163], v[196:199]
    ds_read_b128 v[232:235], v7 offset:46848
    v_add_f32 v244, v244, v245
    v_mfma_f32_16x16x32_bf16 v[196:199], v[236:239], a[164:167], v[196:199]
    s_waitcnt lgkmcnt(3)
    ds_read_b128 v[236:239], v7 offset:47872
    v_mov_b32 v246, v244
    v_mfma_f32_16x16x32_bf16 v[208:211], v[220:223], a[144:147], 0
    s_nop 0
    v_permlane32_swap_b32 v244, v246
    s_waitcnt lgkmcnt(3)
    v_mfma_f32_16x16x32_bf16 v[208:211], v[224:227], a[148:151], v[208:211]
    v_add_f32 v244, v244, v246
    v_cvt_pk_bf16_f32 v128, v196, v197
    v_mfma_f32_16x16x32_bf16 v[212:215], v[220:223], a[168:171], 0
    s_waitcnt lgkmcnt(2)
    ds_write_b32 v10, v244 offset:1024
    v_mfma_f32_16x16x32_bf16 v[208:211], v[228:231], a[152:155], v[208:211]
    v_cvt_pk_bf16_f32 v129, v198, v199
    v_cvt_pk_bf16_f32 v136, v200, v201
    v_mfma_f32_16x16x32_bf16 v[212:215], v[224:227], a[172:175], v[212:215]
    v_cvt_pk_bf16_f32 v137, v202, v203
    v_cvt_pk_bf16_f32 v144, v204, v205
    v_mfma_f32_16x16x32_bf16 v[212:215], v[228:231], a[176:179], v[212:215]
    v_cvt_pk_bf16_f32 v145, v206, v207
    v_mfma_f32_16x16x32_bf16 v[216:219], v[220:223], a[192:195], 0
    ds_read_b128 v[220:223], v7 offset:48896
    v_mfma_f32_16x16x32_bf16 v[216:219], v[224:227], a[196:199], v[216:219]
    ds_read_b128 v[224:227], v7 offset:49920
    v_mfma_f32_16x16x32_bf16 v[216:219], v[228:231], a[200:203], v[216:219]
    s_waitcnt lgkmcnt(2)
    s_barrier
    v_mfma_f32_16x16x32_bf16 v[216:219], v[232:235], a[204:207], v[216:219]
    ds_read_b128 v[240:243], v248 offset:0
    v_mfma_f32_16x16x32_bf16 v[216:219], v[236:239], a[208:211], v[216:219]
    ds_read_b128 v[244:247], v248 offset:16
    v_mfma_f32_16x16x32_bf16 v[212:215], v[232:235], a[180:183], v[212:215]
    s_waitcnt lgkmcnt(3)
    ds_read_b128 v[180:183], v13 offset:0
    v_mfma_f32_16x16x32_bf16 v[216:219], v[220:223], a[212:215], v[216:219]
    ds_read_b128 v[184:187], v13 offset:128
    v_mfma_f32_16x16x32_bf16 v[212:215], v[236:239], a[184:187], v[212:215]
    ds_read_b128 v[188:191], v13 offset:256
    v_mfma_f32_16x16x32_bf16 v[212:215], v[220:223], a[188:191], v[212:215]
    ds_read_b128 v[192:195], v13 offset:400
    v_mfma_f32_16x16x32_bf16 v[208:211], v[232:235], a[156:159], v[208:211]
    s_waitcnt lgkmcnt(5)
    ds_read_b128 v[172:175], v13 offset:528
    v_add_f32 v240, v240, v241
    v_mfma_f32_16x16x32_bf16 v[208:211], v[236:239], a[160:163], v[208:211]
    ds_read_b128 v[176:179], v13 offset:656
    v_add_f32 v242, v242, v243
    v_mfma_f32_16x16x32_bf16 v[208:211], v[220:223], a[164:167], v[208:211]
    s_waitcnt lgkmcnt(5)
    ds_read_b128 v[228:231], v7 offset:50944
    buffer_store_dwordx4 v[180:183], v14, s[40:43], s89 offen offset:0 sc1
    v_mfma_f32_16x16x32_bf16 v[196:199], v[224:227], a[144:147], 0
    ds_read_b128 v[232:235], v7 offset:51968
    v_add_f32 v244, v244, v245
    v_mfma_f32_16x16x32_bf16 v[200:203], v[224:227], a[168:171], 0
    ds_read_b128 v[236:239], v7 offset:52992
    v_add_f32 v246, v246, v247
    v_mfma_f32_16x16x32_bf16 v[204:207], v[224:227], a[192:195], 0
    ds_read_b128 v[220:223], v7 offset:54016
    v_add_f32 v240, v240, v242
    v_add_f32 v244, v244, v246
    v_mul_f32 v240, s59, v240
    v_fma_f32 v241, v240, v240, -s60
    v_fma_f32 v244, v244, s59, -v241
    v_max_f32 v244, s60, v244
    v_rsq_f32 v248, v244
    s_waitcnt lgkmcnt(3)
    v_mfma_f32_16x16x32_bf16 v[196:199], v[228:231], a[148:151], v[196:199]
    s_barrier
    s_waitcnt lgkmcnt(2)
    v_mfma_f32_16x16x32_bf16 v[196:199], v[232:235], a[152:155], v[196:199]
    buffer_store_dwordx4 v[184:187], v14, s[40:43], s89 offen offset:128 sc1
    v_mfma_f32_16x16x32_bf16 v[200:203], v[228:231], a[172:175], v[200:203]
    ds_bpermute_b32 v250, v11, v248 offset:0
    v_mfma_f32_16x16x32_bf16 v[200:203], v[232:235], a[176:179], v[200:203]
    ds_bpermute_b32 v254, v11, v248 offset:64
    v_mfma_f32_16x16x32_bf16 v[204:207], v[228:231], a[196:199], v[204:207]
    ds_read_b128 v[224:227], v7 offset:55040
    v_mul_f32 v249, v240, v248
    v_mfma_f32_16x16x32_bf16 v[204:207], v[232:235], a[200:203], v[204:207]
    s_waitcnt lgkmcnt(4)
    buffer_store_dwordx4 v[188:191], v14, s[40:43], s89 offen offset:256 sc1
    v_mfma_f32_16x16x32_bf16 v[204:207], v[236:239], a[204:207], v[204:207]
    s_waitcnt lgkmcnt(3)
    ds_bpermute_b32 v251, v11, v249 offset:0
    v_mfma_f32_16x16x32_bf16 v[204:207], v[220:223], a[208:211], v[204:207]
    ds_bpermute_b32 v255, v11, v249 offset:64
    v_mfma_f32_16x16x32_bf16 v[200:203], v[236:239], a[180:183], v[200:203]
    ds_read_b128 v[228:231], v7 offset:37632
    v_cvt_pk_bf16_f32 v130, v208, v209
    v_mfma_f32_16x16x32_bf16 v[200:203], v[220:223], a[184:187], v[200:203]
    s_waitcnt lgkmcnt(3)
    buffer_store_dwordx4 v[192:195], v15, s[40:43], s89 offen offset:384 sc1
    v_mfma_f32_16x16x32_bf16 v[204:207], v[224:227], a[212:215], v[204:207]
    ds_read_b128 v[232:235], v7 offset:38656
    v_cvt_pk_bf16_f32 v131, v210, v211
    v_mfma_f32_16x16x32_bf16 v[200:203], v[224:227], a[188:191], v[200:203]
    s_waitcnt lgkmcnt(3)
    v_fma_f32 v246, v68, v250, -v251
    v_fma_f32 v247, v69, v250, -v251
    v_mfma_f32_16x16x32_bf16 v[196:199], v[236:239], a[156:159], v[196:199]
    ds_read_b128 v[236:239], v7 offset:39680
    v_cvt_pk_bf16_f32 v240, v246, v247
    v_mfma_f32_16x16x32_bf16 v[196:199], v[220:223], a[160:163], v[196:199]
    buffer_store_dwordx4 v[172:175], v15, s[40:43], s89 offen offset:512 sc1
    v_mfma_f32_16x16x32_bf16 v[196:199], v[224:227], a[164:167], v[196:199]
    s_waitcnt lgkmcnt(2)
    ds_read_b128 v[220:223], v7 offset:40704
    v_fma_f32 v246, v70, v250, -v251
    v_mfma_f32_16x16x32_bf16 v[208:211], a[72:75], v[228:231], 0
    s_waitcnt lgkmcnt(2)
    ds_read_b128 v[224:227], v7 offset:41728
    v_fma_f32 v247, v71, v250, -v251
    v_mfma_f32_16x16x32_bf16 v[208:211], a[76:79], v[232:235], v[208:211]
    v_cvt_pk_bf16_f32 v241, v246, v247
    v_fma_f32 v246, v72, v250, -v251
    v_mfma_f32_16x16x32_bf16 v[172:175], a[252:255], v[164:167], 0
    s_waitcnt lgkmcnt(2)
    buffer_store_dwordx4 v[176:179], v15, s[40:43], s89 offen offset:640 sc1
    v_mfma_f32_16x16x32_bf16 v[208:211], a[80:83], v[236:239], v[208:211]
    v_fma_f32 v247, v73, v250, -v251
    v_cvt_pk_bf16_f32 v242, v246, v247
    v_mfma_f32_16x16x32_bf16 v[172:175], a[252:255], v[168:171], v[172:175]
    s_waitcnt lgkmcnt(1)
    v_fma_f32 v246, v74, v250, -v251
    v_fma_f32 v247, v75, v250, -v251
    v_mfma_f32_16x16x32_bf16 v[208:211], a[84:87], v[220:223], v[208:211]
    s_waitcnt lgkmcnt(0)
    v_cvt_pk_bf16_f32 v243, v246, v247
    v_fma_f32 v246, v76, v250, -v251
    v_mfma_f32_16x16x32_bf16 v[208:211], a[88:91], v[224:227], v[208:211]
    ds_write_b128 v8, v[240:243] offset:0
    v_fma_f32 v247, v77, v250, -v251
    v_cvt_pk_bf16_f32 v244, v246, v247
    v_fma_f32 v246, v78, v250, -v251
    v_fma_f32 v247, v79, v250, -v251
    v_cvt_pk_bf16_f32 v245, v246, v247
    v_cvt_pk_bf16_f32 v138, v212, v213
    v_cvt_pk_bf16_f32 v139, v214, v215
    v_mfma_f32_16x16x32_bf16 v[212:215], a[96:99], v[228:231], 0
    ds_bpermute_b32 v250, v11, v248 offset:128
    v_mfma_f32_16x16x32_bf16 v[212:215], a[100:103], v[232:235], v[212:215]
    ds_bpermute_b32 v251, v11, v249 offset:128
    v_mfma_f32_16x16x32_bf16 v[212:215], a[104:107], v[236:239], v[212:215]
    ds_write_b64 v9, v[244:245] offset:0
    v_mfma_f32_16x16x32_bf16 v[212:215], a[108:111], v[220:223], v[212:215]
    v_cvt_pk_bf16_f32 v146, v216, v217
    v_cvt_pk_bf16_f32 v147, v218, v219
    v_mfma_f32_16x16x32_bf16 v[216:219], a[120:123], v[228:231], 0
    ds_read_b128 v[228:231], v7 offset:42752
    v_fma_f32 v246, v80, v254, -v255
    v_mfma_f32_16x16x32_bf16 v[216:219], a[124:127], v[232:235], v[216:219]
    ds_read_b128 v[232:235], v7 offset:43776
    v_fma_f32 v247, v81, v254, -v255
    v_mfma_f32_16x16x32_bf16 v[216:219], a[128:131], v[236:239], v[216:219]
    ds_read_b128 v[236:239], v7 offset:44800
    v_cvt_pk_bf16_f32 v240, v246, v247
    v_mfma_f32_16x16x32_bf16 v[216:219], a[132:135], v[220:223], v[216:219]
    ds_read_b128 v[220:223], v7 offset:45824
    v_fma_f32 v246, v82, v254, -v255
    v_mfma_f32_16x16x32_bf16 v[216:219], a[136:139], v[224:227], v[216:219]
    v_fma_f32 v247, v83, v254, -v255
    v_cvt_pk_bf16_f32 v241, v246, v247
    v_mfma_f32_16x16x32_bf16 v[212:215], a[112:115], v[224:227], v[212:215]
    ds_read_b128 v[224:227], v7 offset:46848
    v_fma_f32 v246, v84, v254, -v255
    v_fma_f32 v247, v85, v254, -v255
    v_cvt_pk_bf16_f32 v242, v246, v247
    v_fma_f32 v246, v86, v254, -v255
    s_waitcnt lgkmcnt(4)
    v_mfma_f32_16x16x32_bf16 v[216:219], a[140:143], v[228:231], v[216:219]
    v_fma_f32 v247, v87, v254, -v255
    v_cvt_pk_bf16_f32 v243, v246, v247
    v_mfma_f32_16x16x32_bf16 v[212:215], a[116:119], v[228:231], v[212:215]
    ds_write_b128 v8, v[240:243] offset:6144
    v_mfma_f32_16x16x32_bf16 v[208:211], a[92:95], v[228:231], v[208:211]
    v_fma_f32 v246, v88, v254, -v255
    v_fma_f32 v247, v89, v254, -v255
    v_cvt_pk_bf16_f32 v244, v246, v247
    v_fma_f32 v246, v90, v254, -v255
    v_fma_f32 v247, v91, v254, -v255
    v_cvt_pk_bf16_f32 v245, v246, v247
    v_cvt_pk_bf16_f32 v132, v196, v197
    v_cvt_pk_bf16_f32 v133, v198, v199
    v_mfma_f32_16x16x32_bf16 v[196:199], v[128:131], v[164:167], 0
    ds_read_b128 v[228:231], v7 offset:47872
    v_cvt_pk_bf16_f32 v140, v200, v201
    v_mfma_f32_16x16x32_bf16 v[196:199], v[132:135], v[168:171], v[196:199]
    ds_write_b64 v9, v[244:245] offset:6144
    v_cvt_pk_bf16_f32 v141, v202, v203
    v_mfma_f32_16x16x32_bf16 v[200:203], v[136:139], v[164:167], 0
    v_cvt_pk_bf16_f32 v148, v204, v205
    v_cvt_pk_bf16_f32 v149, v206, v207
    v_mfma_f32_16x16x32_bf16 v[200:203], v[140:143], v[168:171], v[200:203]
    v_fma_f32 v246, v92, v250, -v251
    v_fma_f32 v247, v93, v250, -v251
    v_mfma_f32_16x16x32_bf16 v[204:207], v[144:147], v[164:167], 0
    v_cvt_pk_bf16_f32 v240, v246, v247
    v_fma_f32 v246, v94, v250, -v251
    v_mfma_f32_16x16x32_bf16 v[204:207], v[148:151], v[168:171], v[204:207]
    s_waitcnt lgkmcnt(6)
    v_fma_f32 v247, v95, v250, -v251
    v_cvt_pk_bf16_f32 v241, v246, v247
    v_fma_f32 v246, v96, v250, -v251
    v_fma_f32 v247, v97, v250, -v251
    v_cvt_pk_bf16_f32 v242, v246, v247
    v_fma_f32 v246, v98, v250, -v251
    v_fma_f32 v247, v99, v250, -v251
    v_cvt_pk_bf16_f32 v243, v246, v247
    v_fma_f32 v246, v100, v250, -v251
    v_fma_f32 v247, v101, v250, -v251
    v_cvt_pk_bf16_f32 v244, v246, v247
    v_fma_f32 v246, v102, v250, -v251
    v_fma_f32 v247, v103, v250, -v251
    v_cvt_pk_bf16_f32 v245, v246, v247
    ds_write_b128 v8, v[240:243] offset:12288
    v_cvt_pk_bf16_f32 v158, v208, v209
    v_cvt_pk_bf16_f32 v159, v210, v211
    v_mfma_f32_16x16x32_bf16 v[208:211], a[72:75], v[232:235], 0
    s_waitcnt lgkmcnt(6)
    v_cvt_pk_bf16_f32 v160, v212, v213
    v_cvt_pk_bf16_f32 v161, v214, v215
    v_mfma_f32_16x16x32_bf16 v[208:211], a[76:79], v[236:239], v[208:211]
    v_cvt_pk_bf16_f32 v162, v216, v217
    v_cvt_pk_bf16_f32 v163, v218, v219
    v_mfma_f32_16x16x32_bf16 v[180:183], v[104:107], v[158:161], 0
    v_rcp_f32 v172, v172
    v_mfma_f32_16x16x32_bf16 v[184:187], v[110:113], v[158:161], 0
    v_mul_f32 v196, v172, v196
    v_mul_f32 v197, v172, v197
    v_mfma_f32_16x16x32_bf16 v[188:191], v[116:119], v[158:161], 0
    ds_write_b64 v9, v[244:245] offset:12288
    v_mfma_f32_16x16x32_bf16 v[192:195], v[122:125], v[158:161], v[0:3]
    v_cvt_pk_bf16_f32 v196, v196, v197
    v_mul_f32 v198, v172, v198
    v_mfma_f32_16x16x16_bf16 v[180:183], v[108:109], v[162:163], v[180:183]
    v_mul_f32 v199, v172, v199
    v_cvt_pk_bf16_f32 v197, v198, v199
    v_mfma_f32_16x16x16_bf16 v[184:187], v[114:115], v[162:163], v[184:187]
    v_mul_f32 v200, v172, v200
    v_mul_f32 v201, v172, v201
    v_mfma_f32_16x16x16_bf16 v[188:191], v[120:121], v[162:163], v[188:191]
    v_cvt_pk_bf16_f32 v198, v200, v201
    v_mul_f32 v202, v172, v202
    v_mfma_f32_16x16x16_bf16 v[192:195], v[126:127], v[162:163], v[192:195]
    s_waitcnt lgkmcnt(6)
    v_mul_f32 v203, v172, v203
    v_cvt_pk_bf16_f32 v199, v202, v203
    v_mfma_f32_16x16x32_bf16 v[208:211], a[80:83], v[220:223], v[208:211]
    s_mov_b64 exec, s[80:81]
    ds_write_b128 v8, v[196:199] offset:56832
    s_mov_b64 exec, -1
    v_mfma_f32_16x16x32_bf16 v[212:215], a[96:99], v[232:235], 0
    s_waitcnt lgkmcnt(1)
    s_barrier
    v_mfma_f32_16x16x32_bf16 v[212:215], a[100:103], v[236:239], v[212:215]
    v_mul_f32 v204, v172, v204
    v_mul_f32 v205, v172, v205
    v_mfma_f32_16x16x32_bf16 v[212:215], a[104:107], v[220:223], v[212:215]
    v_cvt_pk_bf16_f32 v200, v204, v205
    v_mul_f32 v206, v172, v206
    v_mfma_f32_16x16x32_bf16 v[216:219], a[120:123], v[232:235], 0
    ds_read_b128 v[232:235], v7 offset:48896
    v_mul_f32 v207, v172, v207
    v_mfma_f32_16x16x32_bf16 v[216:219], a[124:127], v[236:239], v[216:219]
    ds_read_b128 v[236:239], v7 offset:49920
    v_cvt_pk_bf16_f32 v201, v206, v207
    v_mfma_f32_16x16x32_bf16 v[216:219], a[128:131], v[220:223], v[216:219]
    s_mov_b64 exec, s[80:81]
    ds_write_b64 v9, v[200:201] offset:56832
    s_mov_b64 exec, -1
    v_mfma_f32_16x16x32_bf16 v[216:219], a[132:135], v[224:227], v[216:219]
    s_mov_b32 s80, 0x10001000
    v_max3_f32 v254, v180, v181, v182
    v_max3_f32 v255, v183, v184, v185
    v_mfma_f32_16x16x32_bf16 v[216:219], a[136:139], v[228:231], v[216:219]
    s_mov_b32 s81, 0x10001000
    ds_read_b128 v[220:223], v7 offset:50944
    v_max3_f32 v254, v254, v186, v187
    v_mfma_f32_16x16x32_bf16 v[212:215], a[108:111], v[224:227], v[212:215]
    s_waitcnt lgkmcnt(3)
    v_max3_f32 v255, v255, v188, v189
    v_max3_f32 v254, v254, v190, v191
    v_mfma_f32_16x16x32_bf16 v[216:219], a[140:143], v[232:235], v[216:219]
    v_max3_f32 v254, v254, v255, v192
    v_mov_b32 v255, v254
    v_mfma_f32_16x16x32_bf16 v[212:215], a[112:115], v[228:231], v[212:215]
    s_nop 0
    v_permlane16_swap_b32 v254, v255
    v_mfma_f32_16x16x32_bf16 v[212:215], a[116:119], v[232:235], v[212:215]
    v_max_f32 v254, v254, v255
    v_mov_b32 v255, v254
    v_mfma_f32_16x16x32_bf16 v[208:211], a[84:87], v[224:227], v[208:211]
    ds_read_b128 v[224:227], v7 offset:51968
    v_cvt_pk_bf16_f32 v162, v216, v217
    v_mfma_f32_16x16x32_bf16 v[208:211], a[88:91], v[228:231], v[208:211]
    ds_read_b128 v[228:231], v7 offset:52992
    v_cvt_pk_bf16_f32 v163, v218, v219
    v_mfma_f32_16x16x32_bf16 v[208:211], a[92:95], v[232:235], v[208:211]
    s_waitcnt lgkmcnt(4)
    ds_read_b128 v[232:235], v7 offset:54016
    v_cvt_pk_bf16_f32 v160, v212, v213
    v_mfma_f32_16x16x32_bf16 v[216:219], a[120:123], v[236:239], 0
    v_cvt_pk_bf16_f32 v161, v214, v215
    v_permlane32_swap_b32 v254, v255
    v_mfma_f32_16x16x32_bf16 v[212:215], a[96:99], v[236:239], 0
    s_nop 0
    v_cvt_pk_bf16_f32 v158, v208, v209
    v_cvt_pk_bf16_f32 v159, v210, v211
    v_mfma_f32_16x16x32_bf16 v[208:211], a[72:75], v[236:239], 0
    ds_read_b128 v[236:239], v7 offset:55040
    v_max_f32 v254, v254, v255
    v_mfma_f32_16x16x32_bf16 v[164:167], v[104:107], v[158:161], 0
    v_mul_f32 v254, s54, v254
    v_fma_f32 v180, v180, s54, -v254
    v_mfma_f32_16x16x32_bf16 v[168:171], v[110:113], v[158:161], 0
    v_fma_f32 v181, v181, s54, -v254
    v_fma_f32 v182, v182, s54, -v254
    v_mfma_f32_16x16x32_bf16 v[172:175], v[116:119], v[158:161], 0
    v_fma_f32 v183, v183, s54, -v254
    v_fma_f32 v184, v184, s54, -v254
    v_mfma_f32_16x16x32_bf16 v[176:179], v[122:125], v[158:161], v[0:3]
    v_fma_f32 v185, v185, s54, -v254
    v_fma_f32 v186, v186, s54, -v254
    v_mfma_f32_16x16x16_bf16 v[164:167], v[108:109], v[162:163], v[164:167]
    v_fma_f32 v187, v187, s54, -v254
    v_fma_f32 v188, v188, s54, -v254
    v_mfma_f32_16x16x16_bf16 v[168:171], v[114:115], v[162:163], v[168:171]
    v_fma_f32 v189, v189, s54, -v254
    v_fma_f32 v190, v190, s54, -v254
    v_mfma_f32_16x16x16_bf16 v[172:175], v[120:121], v[162:163], v[172:175]
    v_fma_f32 v191, v191, s54, -v254
    v_fma_f32 v192, v192, s54, -v254
    v_mfma_f32_16x16x16_bf16 v[176:179], v[126:127], v[162:163], v[176:179]
    s_waitcnt lgkmcnt(4)
    v_exp_f32 v180, v180
    v_mfma_f32_16x16x32_bf16 v[208:211], a[76:79], v[220:223], v[208:211]
    s_waitcnt lgkmcnt(3)
    v_exp_f32 v181, v181
    v_mfma_f32_16x16x32_bf16 v[208:211], a[80:83], v[224:227], v[208:211]
    v_exp_f32 v182, v182
    v_mfma_f32_16x16x32_bf16 v[212:215], a[100:103], v[220:223], v[212:215]
    v_cvt_pk_bf16_f32 v180, v180, v181
    v_exp_f32 v183, v183
    v_mfma_f32_16x16x32_bf16 v[212:215], a[104:107], v[224:227], v[212:215]
    v_exp_f32 v184, v184
    v_mfma_f32_16x16x32_bf16 v[216:219], a[124:127], v[220:223], v[216:219]
    ds_read_b128 v[220:223], v7 offset:0
    v_cvt_pk_bf16_f32 v181, v182, v183
    v_mfma_f32_16x16x32_bf16 v[216:219], a[128:131], v[224:227], v[216:219]
    s_waitcnt lgkmcnt(3)
    ds_read_b128 v[224:227], v7 offset:1024
    v_exp_f32 v185, v185
    v_mfma_f32_16x16x32_bf16 v[216:219], a[132:135], v[228:231], v[216:219]
    s_waitcnt lgkmcnt(3)
    v_exp_f32 v186, v186
    v_mfma_f32_16x16x32_bf16 v[216:219], a[136:139], v[232:235], v[216:219]
    s_waitcnt lgkmcnt(2)
    v_cvt_pk_bf16_f32 v182, v184, v185
    v_exp_f32 v187, v187
    v_mfma_f32_16x16x32_bf16 v[216:219], a[140:143], v[236:239], v[216:219]
    v_exp_f32 v188, v188
    v_mfma_f32_16x16x32_bf16 v[212:215], a[108:111], v[228:231], v[212:215]
    v_cvt_pk_bf16_f32 v183, v186, v187
    v_exp_f32 v189, v189
    v_mfma_f32_16x16x32_bf16 v[212:215], a[112:115], v[232:235], v[212:215]
    v_exp_f32 v190, v190
    v_mfma_f32_16x16x32_bf16 v[196:199], v[128:131], v[180:183], 0
    v_cvt_pk_bf16_f32 v184, v188, v189
    v_exp_f32 v191, v191
    v_mfma_f32_16x16x32_bf16 v[200:203], v[136:139], v[180:183], 0
    v_exp_f32 v192, v192
    v_mfma_f32_16x16x32_bf16 v[204:207], v[144:147], v[180:183], 0
    v_cvt_pk_bf16_f32 v185, v190, v191
    v_mov_b32 v187, 0
    v_mfma_f32_16x16x32_bf16 v[188:191], a[252:255], v[180:183], 0
    v_cvt_pk_bf16_f32 v186, v192, 0
    v_cvt_pk_bf16_f32 v162, v216, v217
    v_mfma_f32_16x16x32_bf16 v[212:215], a[116:119], v[236:239], v[212:215]
    v_cvt_pk_bf16_f32 v163, v218, v219
    v_max3_f32 v252, v164, v165, v166
    v_mfma_f32_16x16x32_bf16 v[188:191], a[252:255], v[184:187], v[188:191]
    v_max3_f32 v253, v167, v168, v169
    v_max3_f32 v252, v252, v170, v171
    v_mfma_f32_16x16x32_bf16 v[196:199], v[132:135], v[184:187], v[196:199]
    v_max3_f32 v253, v253, v172, v173
    v_max3_f32 v252, v252, v174, v175
    v_mfma_f32_16x16x32_bf16 v[200:203], v[140:143], v[184:187], v[200:203]
    v_cvt_pk_bf16_f32 v160, v212, v213
    v_cvt_pk_bf16_f32 v161, v214, v215
    v_mfma_f32_16x16x32_bf16 v[204:207], v[148:151], v[184:187], v[204:207]
    v_rcp_f32 v188, v188
    v_mfma_f32_16x16x32_bf16 v[208:211], a[84:87], v[228:231], v[208:211]
    ds_read_b128 v[228:231], v7 offset:2048
    v_mul_f32 v196, v188, v196
    v_mfma_f32_16x16x32_bf16 v[208:211], a[88:91], v[232:235], v[208:211]
    ds_read_b128 v[232:235], v7 offset:3072
    v_mul_f32 v197, v188, v197
    v_mfma_f32_16x16x32_bf16 v[208:211], a[92:95], v[236:239], v[208:211]
    s_waitcnt lgkmcnt(3)
    ds_read_b128 v[236:239], v7 offset:4096
    v_cvt_pk_bf16_f32 v196, v196, v197
    v_mfma_f32_16x16x32_bf16 v[212:215], a[24:27], v[220:223], 0
    s_waitcnt lgkmcnt(3)
    v_mul_f32 v198, v188, v198
    v_mul_f32 v199, v188, v199
    v_mfma_f32_16x16x32_bf16 v[212:215], a[28:31], v[224:227], v[212:215]
    v_cvt_pk_bf16_f32 v197, v198, v199
    v_mul_f32 v200, v188, v200
    v_mfma_f32_16x16x32_bf16 v[216:219], a[48:51], v[220:223], 0
    v_mul_f32 v201, v188, v201
    v_cvt_pk_bf16_f32 v198, v200, v201
    v_mfma_f32_16x16x32_bf16 v[216:219], a[52:55], v[224:227], v[216:219]
    s_waitcnt lgkmcnt(2)
    v_mul_f32 v202, v188, v202
    v_mul_f32 v203, v188, v203
    v_mfma_f32_16x16x32_bf16 v[212:215], a[32:35], v[228:231], v[212:215]
    v_cvt_pk_bf16_f32 v199, v202, v203
    v_mul_f32 v204, v188, v204
    v_mfma_f32_16x16x32_bf16 v[216:219], a[56:59], v[228:231], v[216:219]
    s_waitcnt lgkmcnt(1)
    ds_write_b128 v8, v[196:199] offset:19200
    v_mfma_f32_16x16x32_bf16 v[216:219], a[60:63], v[232:235], v[216:219]
    s_waitcnt lgkmcnt(1)
    v_mul_f32 v205, v188, v205
    v_cvt_pk_bf16_f32 v200, v204, v205
    v_mfma_f32_16x16x32_bf16 v[216:219], a[64:67], v[236:239], v[216:219]
    v_mul_f32 v206, v188, v206
    v_mul_f32 v207, v188, v207
    v_mfma_f32_16x16x32_bf16 v[212:215], a[36:39], v[232:235], v[212:215]
    v_cvt_pk_bf16_f32 v201, v206, v207
    v_cvt_pk_bf16_f32 v158, v208, v209
    v_mfma_f32_16x16x32_bf16 v[212:215], a[40:43], v[236:239], v[212:215]
    v_cvt_pk_bf16_f32 v159, v210, v211
    v_max3_f32 v252, v252, v253, v176
    v_mfma_f32_16x16x32_bf16 v[208:211], a[0:3], v[220:223], 0
    ds_write_b64 v9, v[200:201] offset:19200
    v_mfma_f32_16x16x32_bf16 v[180:183], v[104:107], v[158:161], 0
    ds_read_b128 v[220:223], v7 offset:5120
    v_mov_b32 v253, v252
    v_mfma_f32_16x16x32_bf16 v[184:187], v[110:113], v[158:161], 0
    s_nop 0
    v_permlane16_swap_b32 v252, v253
    v_mfma_f32_16x16x32_bf16 v[188:191], v[116:119], v[158:161], 0
    v_max_f32 v252, v252, v253
    v_mov_b32 v253, v252
    v_mfma_f32_16x16x32_bf16 v[192:195], v[122:125], v[158:161], v[0:3]
    ds_read_b64_tr_b16 v[158:159], v18 offset:4608
    ds_read_b64_tr_b16 v[160:161], v18 offset:6144
    v_mfma_f32_16x16x16_bf16 v[180:183], v[108:109], v[162:163], v[180:183]
    v_permlane32_swap_b32 v252, v253
    v_mfma_f32_16x16x16_bf16 v[184:187], v[114:115], v[162:163], v[184:187]
    v_max_f32 v252, v252, v253
    v_mul_f32 v252, s54, v252
    v_mfma_f32_16x16x16_bf16 v[188:191], v[120:121], v[162:163], v[188:191]
    v_fma_f32 v164, v164, s54, -v252
    v_fma_f32 v165, v165, s54, -v252
    v_mfma_f32_16x16x16_bf16 v[192:195], v[126:127], v[162:163], v[192:195]
    v_fma_f32 v166, v166, s54, -v252
    v_fma_f32 v167, v167, s54, -v252
    v_mfma_f32_16x16x32_bf16 v[208:211], a[4:7], v[224:227], v[208:211]
    ds_read_b128 v[224:227], v7 offset:6144
    v_fma_f32 v168, v168, s54, -v252
    v_mfma_f32_16x16x32_bf16 v[208:211], a[8:11], v[228:231], v[208:211]
    s_waitcnt lgkmcnt(3)
    ds_read_b128 v[228:231], v7 offset:7168
    v_fma_f32 v169, v169, s54, -v252
    v_mfma_f32_16x16x32_bf16 v[216:219], a[68:71], v[220:223], v[216:219]
    v_fma_f32 v170, v170, s54, -v252
    v_fma_f32 v171, v171, s54, -v252
    v_mfma_f32_16x16x32_bf16 v[212:215], a[44:47], v[220:223], v[212:215]
    v_fma_f32 v172, v172, s54, -v252
    v_fma_f32 v173, v173, s54, -v252
    v_mfma_f32_16x16x32_bf16 v[208:211], a[12:15], v[232:235], v[208:211]
    ds_read_b128 v[232:235], v7 offset:8192
    v_fma_f32 v174, v174, s54, -v252
    v_mfma_f32_16x16x32_bf16 v[208:211], a[16:19], v[236:239], v[208:211]
    ds_read_b128 v[236:239], v7 offset:9216
    v_fma_f32 v175, v175, s54, -v252
    v_mfma_f32_16x16x32_bf16 v[208:211], a[20:23], v[220:223], v[208:211]
    ds_read_b128 v[220:223], v7 offset:10240
    v_fma_f32 v176, v176, s54, -v252
    v_exp_f32 v164, v164
    v_exp_f32 v165, v165
    v_exp_f32 v166, v166
    v_cvt_pk_bf16_f32 v164, v164, v165
    v_exp_f32 v167, v167
    v_exp_f32 v168, v168
    v_cvt_pk_bf16_f32 v165, v166, v167
    v_exp_f32 v169, v169
    v_exp_f32 v170, v170
    v_cvt_pk_bf16_f32 v166, v168, v169
    v_exp_f32 v171, v171
    v_exp_f32 v172, v172
    v_cvt_pk_bf16_f32 v167, v170, v171
    v_exp_f32 v173, v173
    v_exp_f32 v174, v174
    v_mfma_f32_16x16x32_bf16 v[196:199], v[128:131], v[164:167], 0
    v_cvt_pk_bf16_f32 v168, v172, v173
    v_exp_f32 v175, v175
    v_mfma_f32_16x16x32_bf16 v[200:203], v[136:139], v[164:167], 0
    v_exp_f32 v176, v176
    v_mfma_f32_16x16x32_bf16 v[204:207], v[144:147], v[164:167], 0
    v_cvt_pk_bf16_f32 v169, v174, v175
    v_mov_b32 v171, 0
    v_mfma_f32_16x16x32_bf16 v[172:175], a[252:255], v[164:167], 0
    v_cvt_pk_bf16_f32 v170, v176, 0
    v_cvt_pk_bf16_f32 v104, v208, v209
    v_cvt_pk_bf16_f32 v105, v210, v211
    v_mfma_f32_16x16x32_bf16 v[172:175], a[252:255], v[168:171], v[172:175]
    v_cvt_pk_bf16_f32 v106, v212, v213
    v_cvt_pk_bf16_f32 v107, v214, v215
    v_mfma_f32_16x16x32_bf16 v[196:199], v[132:135], v[168:171], v[196:199]
    v_cvt_pk_bf16_f32 v108, v216, v217
    v_cvt_pk_bf16_f32 v109, v218, v219
    v_mfma_f32_16x16x32_bf16 v[200:203], v[140:143], v[168:171], v[200:203]
    v_max3_f32 v254, v180, v181, v182
    v_max3_f32 v255, v183, v184, v185
    v_mfma_f32_16x16x32_bf16 v[204:207], v[148:151], v[168:171], v[204:207]
    v_rcp_f32 v172, v172
    v_mfma_f32_16x16x32_bf16 v[164:167], v[104:107], v[152:155], 0
    v_mul_f32 v196, v172, v196
    v_mul_f32 v197, v172, v197
    v_cvt_pk_bf16_f32 v196, v196, v197
    v_mul_f32 v198, v172, v198
    v_mul_f32 v199, v172, v199
    v_cvt_pk_bf16_f32 v197, v198, v199
    v_mfma_f32_16x16x16_bf16 v[164:167], v[108:109], v[156:157], v[164:167]
    s_waitcnt lgkmcnt(4)
    v_mul_f32 v200, v172, v200
    v_mul_f32 v201, v172, v201
    v_cvt_pk_bf16_f32 v198, v200, v201
    v_mul_f32 v202, v172, v202
    v_mul_f32 v203, v172, v203
    v_cvt_pk_bf16_f32 v199, v202, v203
    v_mul_f32 v204, v172, v204
    v_mul_f32 v205, v172, v205
    v_cvt_pk_bf16_f32 v200, v204, v205
    v_mul_f32 v206, v172, v206
    v_mul_f32 v207, v172, v207
    v_cvt_pk_bf16_f32 v201, v206, v207
    v_mfma_f32_16x16x32_bf16 v[204:207], a[48:51], v[224:227], 0
    ds_write_b128 v8, v[196:199] offset:25344
    v_mfma_f32_16x16x32_bf16 v[196:199], a[0:3], v[224:227], 0
    s_waitcnt lgkmcnt(4)
    v_max3_f32 v254, v254, v186, v187
    v_max3_f32 v255, v255, v188, v189
    v_mfma_f32_16x16x32_bf16 v[196:199], a[4:7], v[228:231], v[196:199]
    s_waitcnt lgkmcnt(3)
    v_max3_f32 v254, v254, v190, v191
    v_max3_f32 v254, v254, v255, v192
    v_mfma_f32_16x16x32_bf16 v[196:199], a[8:11], v[232:235], v[196:199]
    v_mov_b32 v255, v254
    v_mov_b32 v0, 0xff800000
    v_mfma_f32_16x16x32_bf16 v[204:207], a[52:55], v[228:231], v[204:207]
    v_permlane16_swap_b32 v254, v255
    v_mfma_f32_16x16x32_bf16 v[204:207], a[56:59], v[232:235], v[204:207]
    ds_write_b64 v9, v[200:201] offset:25344
    v_mfma_f32_16x16x32_bf16 v[200:203], a[24:27], v[224:227], 0
    ds_read_b128 v[224:227], v7 offset:11264
    v_max_f32 v254, v254, v255
    v_mfma_f32_16x16x32_bf16 v[200:203], a[28:31], v[228:231], v[200:203]
    ds_read_b128 v[228:231], v7 offset:12288
    v_mov_b32 v255, v254
    v_mfma_f32_16x16x32_bf16 v[200:203], a[32:35], v[232:235], v[200:203]
    s_waitcnt lgkmcnt(5)
    ds_read_b128 v[232:235], v7 offset:13312
    v_permlane32_swap_b32 v254, v255
    v_mfma_f32_16x16x32_bf16 v[204:207], a[60:63], v[236:239], v[204:207]
    s_waitcnt lgkmcnt(5)
    v_max_f32 v254, v254, v255
    v_mul_f32 v254, s54, v254
    v_mfma_f32_16x16x32_bf16 v[204:207], a[64:67], v[220:223], v[204:207]
    v_fma_f32 v180, v180, s54, -v254
    v_fma_f32 v181, v181, s54, -v254
    v_mfma_f32_16x16x32_bf16 v[200:203], a[36:39], v[236:239], v[200:203]
    v_fma_f32 v182, v182, s54, -v254
    v_fma_f32 v183, v183, s54, -v254
    v_mfma_f32_16x16x32_bf16 v[200:203], a[40:43], v[220:223], v[200:203]
    s_waitcnt lgkmcnt(2)
    v_fma_f32 v184, v184, s54, -v254
    v_fma_f32 v185, v185, s54, -v254
    v_mfma_f32_16x16x32_bf16 v[204:207], a[68:71], v[224:227], v[204:207]
    v_fma_f32 v186, v186, s54, -v254
    v_fma_f32 v187, v187, s54, -v254
    v_mfma_f32_16x16x32_bf16 v[200:203], a[44:47], v[224:227], v[200:203]
    v_fma_f32 v188, v188, s54, -v254
    v_fma_f32 v189, v189, s54, -v254
    v_mfma_f32_16x16x32_bf16 v[196:199], a[12:15], v[236:239], v[196:199]
    ds_read_b128 v[236:239], v7 offset:14336
    v_fma_f32 v190, v190, s54, -v254
    v_mfma_f32_16x16x32_bf16 v[196:199], a[16:19], v[220:223], v[196:199]
    ds_read_b128 v[220:223], v7 offset:15360
    v_fma_f32 v191, v191, s54, -v254
    v_mfma_f32_16x16x32_bf16 v[196:199], a[20:23], v[224:227], v[196:199]
    ds_read_b128 v[224:227], v7 offset:16384
    v_fma_f32 v192, v192, s54, -v254
    v_exp_f32 v180, v180
    v_exp_f32 v181, v181
    v_exp_f32 v182, v182
    v_cvt_pk_bf16_f32 v180, v180, v181
    v_exp_f32 v183, v183
    v_exp_f32 v184, v184
    v_cvt_pk_bf16_f32 v181, v182, v183
    v_exp_f32 v185, v185
    v_exp_f32 v186, v186
    v_cvt_pk_bf16_f32 v182, v184, v185
    v_exp_f32 v187, v187
    v_exp_f32 v188, v188
    v_cvt_pk_bf16_f32 v183, v186, v187
    v_exp_f32 v189, v189
    v_exp_f32 v190, v190
    v_mfma_f32_16x16x32_bf16 v[208:211], v[128:131], v[180:183], 0
    ds_read_b64_tr_b16 v[128:129], v18 offset:0
    ds_read_b64_tr_b16 v[130:131], v18 offset:1536
    v_mfma_f32_16x16x32_bf16 v[212:215], v[136:139], v[180:183], 0
    ds_read_b64_tr_b16 v[136:137], v18 offset:32
    ds_read_b64_tr_b16 v[138:139], v18 offset:1568
    v_mfma_f32_16x16x32_bf16 v[216:219], v[144:147], v[180:183], 0
    ds_read_b64_tr_b16 v[144:145], v18 offset:64
    ds_read_b64_tr_b16 v[146:147], v18 offset:1600
    v_cvt_pk_bf16_f32 v184, v188, v189
    v_exp_f32 v191, v191
    v_exp_f32 v192, v192
    v_cvt_pk_bf16_f32 v185, v190, v191
    v_mfma_f32_16x16x32_bf16 v[188:191], a[252:255], v[180:183], 0
    v_mov_b32 v187, 0
    v_cvt_pk_bf16_f32 v186, v192, 0
    v_cvt_pk_bf16_f32 v110, v196, v197
    v_cvt_pk_bf16_f32 v111, v198, v199
    v_mfma_f32_16x16x32_bf16 v[188:191], a[252:255], v[184:187], v[188:191]
    v_cvt_pk_bf16_f32 v112, v200, v201
    v_cvt_pk_bf16_f32 v113, v202, v203
    v_mfma_f32_16x16x32_bf16 v[208:211], v[132:135], v[184:187], v[208:211]
    v_cvt_pk_bf16_f32 v114, v204, v205
    v_cvt_pk_bf16_f32 v115, v206, v207
    v_mfma_f32_16x16x32_bf16 v[212:215], v[140:143], v[184:187], v[212:215]
    v_cndmask_b32_e64 v0, v0, 0, vcc
    v_max3_f32 v252, v164, v165, v166
    v_mfma_f32_16x16x32_bf16 v[216:219], v[148:151], v[184:187], v[216:219]
    s_waitcnt lgkmcnt(10)
    v_rcp_f32 v188, v188
    v_mfma_f32_16x16x32_bf16 v[196:199], a[0:3], v[228:231], 0
    s_waitcnt lgkmcnt(9)
    v_mul_f32 v208, v188, v208
    v_mul_f32 v209, v188, v209
    v_mfma_f32_16x16x32_bf16 v[196:199], a[4:7], v[232:235], v[196:199]
    s_waitcnt lgkmcnt(8)
    v_cvt_pk_bf16_f32 v208, v208, v209
    v_mul_f32 v210, v188, v210
    v_mfma_f32_16x16x32_bf16 v[196:199], a[8:11], v[236:239], v[196:199]
    v_mul_f32 v211, v188, v211
    v_cvt_pk_bf16_f32 v209, v210, v211
    v_mfma_f32_16x16x32_bf16 v[200:203], a[24:27], v[228:231], 0
    v_mul_f32 v212, v188, v212
    v_mul_f32 v213, v188, v213
    v_mfma_f32_16x16x32_bf16 v[200:203], a[28:31], v[232:235], v[200:203]
    v_cvt_pk_bf16_f32 v210, v212, v213
    v_mul_f32 v214, v188, v214
    v_mfma_f32_16x16x32_bf16 v[200:203], a[32:35], v[236:239], v[200:203]
    v_mul_f32 v215, v188, v215
    v_cvt_pk_bf16_f32 v211, v214, v215
    v_mfma_f32_16x16x32_bf16 v[204:207], a[48:51], v[228:231], 0
    ds_write_b128 v8, v[208:211] offset:31488
    v_mfma_f32_16x16x32_bf16 v[204:207], a[52:55], v[232:235], v[204:207]
    v_mul_f32 v216, v188, v216
    v_mul_f32 v217, v188, v217
    v_mfma_f32_16x16x32_bf16 v[204:207], a[56:59], v[236:239], v[204:207]
    s_waitcnt lgkmcnt(8)
    ds_read_b128 v[228:231], v7 offset:17408
    v_cvt_pk_bf16_f32 v212, v216, v217
    v_mfma_f32_16x16x32_bf16 v[204:207], a[60:63], v[220:223], v[204:207]
    s_waitcnt lgkmcnt(8)
    ds_read_b128 v[232:235], v7 offset:0
    v_mul_f32 v218, v188, v218
    v_mfma_f32_16x16x32_bf16 v[204:207], a[64:67], v[224:227], v[204:207]
    ds_read_b128 v[236:239], v7 offset:1024
    v_mul_f32 v219, v188, v219
    v_mfma_f32_16x16x32_bf16 v[200:203], a[36:39], v[220:223], v[200:203]
    v_cvt_pk_bf16_f32 v213, v218, v219
    v_subrev_u32 v240, 95232, v7
    v_mfma_f32_16x16x32_bf16 v[200:203], a[40:43], v[224:227], v[200:203]
    ds_write_b64 v9, v[212:213] offset:31488
    v_mfma_f32_16x16x32_bf16 v[196:199], a[12:15], v[220:223], v[196:199]
    v_lshrrev_b32 v242, 6, v240
    v_lshl_add_u32 v242, v242, 4, s65
    v_mfma_f32_16x16x32_bf16 v[196:199], a[16:19], v[224:227], v[196:199]
    s_waitcnt lgkmcnt(3)
    ds_read_b128 v[20:23], v242 offset:0
    v_bfe_u32 v241, v240, 6, 2
    v_mfma_f32_16x16x32_bf16 v[204:207], a[68:71], v[228:231], v[204:207]
    ds_read_b128 v[24:27], v242 offset:256
    v_mul_u32_u24 v241, 400, v241
    v_mfma_f32_16x16x32_bf16 v[200:203], a[44:47], v[228:231], v[200:203]
    ds_read_b128 v[28:31], v242 offset:512
    v_bfe_u32 v243, v240, 8, 2
    v_mfma_f32_16x16x32_bf16 v[196:199], a[20:23], v[228:231], v[196:199]
    ds_read_b128 v[228:231], v7 offset:4096
    v_lshl_add_u32 v241, v243, 3, v241
    v_mfma_f32_16x16x32_bf16 v[168:171], v[110:113], v[152:155], 0
    v_cvt_pk_bf16_f32 v120, v204, v205
    v_cvt_pk_bf16_f32 v121, v206, v207
    v_mfma_f32_16x16x32_bf16 v[176:179], v[122:125], v[152:155], v[0:3]
    s_waitcnt lgkmcnt(4)
    s_barrier
    v_mfma_f32_16x16x32_bf16 v[208:211], a[72:75], v[232:235], 0
    ds_read_b128 v[180:183], v7 offset:21248
    v_cvt_pk_bf16_f32 v116, v196, v197
    v_mfma_f32_16x16x16_bf16 v[168:171], v[114:115], v[156:157], v[168:171]
    ds_read_b128 v[184:187], v7 offset:27392
    v_cvt_pk_bf16_f32 v117, v198, v199
    v_mfma_f32_16x16x16_bf16 v[176:179], v[126:127], v[156:157], v[176:179]
    ds_read_b128 v[188:191], v7 offset:33536
    v_cvt_pk_bf16_f32 v118, v200, v201
    v_mfma_f32_16x16x32_bf16 v[208:211], a[76:79], v[236:239], v[208:211]
    ds_read_b128 v[192:195], v7 offset:22272
    v_cvt_pk_bf16_f32 v119, v202, v203
    v_mfma_f32_16x16x32_bf16 v[212:215], a[96:99], v[232:235], 0
    ds_read_b128 v[220:223], v7 offset:28416
    v_max3_f32 v253, v167, v168, v169
    v_mfma_f32_16x16x32_bf16 v[172:175], v[116:119], v[152:155], 0
    ds_read_b128 v[224:227], v7 offset:34560
    v_max3_f32 v252, v252, v170, v171
    v_mfma_f32_16x16x32_bf16 v[212:215], a[100:103], v[236:239], v[212:215]
    s_waitcnt lgkmcnt(5)
    v_add_u32 v241, s61, v241
    v_and_b32 v243, 48, v240
    v_mfma_f32_16x16x32_bf16 v[32:35], v[128:131], v[180:183], v[32:35]
    v_lshl_add_u32 v241, v243, 8, v241
    v_add_u32 v243, s66, v240
    v_mfma_f32_16x16x16_bf16 v[172:175], v[120:121], v[156:157], v[172:175]
    s_waitcnt lgkmcnt(4)
    v_add_u32 v244, s67, v240
    v_mov_b32 v245, 0x80000000
    v_mfma_f32_16x16x32_bf16 v[44:47], v[128:131], v[184:187], v[44:47]
    s_waitcnt lgkmcnt(3)
    v_cmp_gt_u32 vcc, 384, v240
    v_mfma_f32_16x16x32_bf16 v[56:59], v[128:131], v[188:191], v[56:59]
    ds_read_b64_tr_b16 v[128:129], v18 offset:4640
    ds_read_b64_tr_b16 v[130:131], v18 offset:6176
    v_mfma_f32_16x16x32_bf16 v[36:39], v[136:139], v[180:183], v[36:39]
    v_max3_f32 v253, v253, v172, v173
    v_max3_f32 v252, v252, v174, v175
    v_mfma_f32_16x16x32_bf16 v[48:51], v[136:139], v[184:187], v[48:51]
    v_max3_f32 v252, v252, v253, v176
    v_mov_b32 v253, v252
    v_mfma_f32_16x16x32_bf16 v[60:63], v[136:139], v[188:191], v[60:63]
    ds_read_b64_tr_b16 v[136:137], v18 offset:4672
    ds_read_b64_tr_b16 v[138:139], v18 offset:6208
    v_mfma_f32_16x16x32_bf16 v[40:43], v[144:147], v[180:183], v[40:43]
    ds_read_b128 v[180:183], v7 offset:24320
    v_permlane16_swap_b32 v252, v253
    v_mfma_f32_16x16x32_bf16 v[52:55], v[144:147], v[184:187], v[52:55]
    ds_read_b128 v[184:187], v7 offset:30464
    v_max_f32 v252, v252, v253
    v_mfma_f32_16x16x32_bf16 v[64:67], v[144:147], v[188:191], v[64:67]
    s_waitcnt lgkmcnt(8)
    ds_read_b64_tr_b16 v[144:145], v18 offset:3072
    ds_read_b64_tr_b16 v[146:147], v18 offset:7680
    v_mfma_f32_16x16x32_bf16 v[32:35], v[158:161], v[192:195], v[32:35]
    s_waitcnt lgkmcnt(9)
    ds_read_b128 v[188:191], v7 offset:36608
    v_mov_b32 v253, v252
    v_mfma_f32_16x16x32_bf16 v[44:47], v[158:161], v[220:223], v[44:47]
    s_nop 0
    v_permlane32_swap_b32 v252, v253
    s_waitcnt lgkmcnt(9)
    v_mfma_f32_16x16x32_bf16 v[56:59], v[158:161], v[224:227], v[56:59]
    s_waitcnt lgkmcnt(7)
    ds_read_b64_tr_b16 v[158:159], v18 offset:3104
    ds_read_b64_tr_b16 v[160:161], v18 offset:7712
    v_mfma_f32_16x16x32_bf16 v[36:39], v[128:131], v[192:195], v[36:39]
    v_max_f32 v252, v252, v253
    v_mul_f32 v252, s54, v252
    v_mfma_f32_16x16x32_bf16 v[48:51], v[128:131], v[220:223], v[48:51]
    s_andn2_b64 exec, -1, s[80:81]
    v_mov_b32 v252, 0x7f800000
    s_mov_b64 exec, -1
    v_mfma_f32_16x16x32_bf16 v[60:63], v[128:131], v[224:227], v[60:63]
    s_waitcnt lgkmcnt(7)
    ds_read_b64_tr_b16 v[128:129], v18 offset:3136
    ds_read_b64_tr_b16 v[130:131], v18 offset:7744
    v_mfma_f32_16x16x32_bf16 v[40:43], v[136:139], v[192:195], v[40:43]
    v_fma_f32 v164, v164, s54, -v252
    v_fma_f32 v165, v165, s54, -v252
    v_mfma_f32_16x16x32_bf16 v[52:55], v[136:139], v[220:223], v[52:55]
    ds_read_b128 v[220:223], v7 offset:2048
    v_fma_f32 v166, v166, s54, -v252
    v_mfma_f32_16x16x32_bf16 v[64:67], v[136:139], v[224:227], v[64:67]
    s_waitcnt lgkmcnt(6)
    ds_read_b128 v[224:227], v7 offset:3072
    v_fma_f32 v167, v167, s54, -v252
    v_mfma_f32_16x16x32_bf16 v[32:35], v[144:147], v[180:183], v[32:35]
    v_fma_f32 v168, v168, s54, -v252
    v_fma_f32 v169, v169, s54, -v252
    v_mfma_f32_16x16x32_bf16 v[44:47], v[144:147], v[184:187], v[44:47]
    s_waitcnt lgkmcnt(6)
    v_fma_f32 v170, v170, s54, -v252
    v_fma_f32 v171, v171, s54, -v252
    v_mfma_f32_16x16x32_bf16 v[56:59], v[144:147], v[188:191], v[56:59]
    s_waitcnt lgkmcnt(4)
    v_fma_f32 v172, v172, s54, -v252
    v_fma_f32 v173, v173, s54, -v252
    v_mfma_f32_16x16x32_bf16 v[36:39], v[158:161], v[180:183], v[36:39]
    v_fma_f32 v174, v174, s54, -v252
    v_fma_f32 v175, v175, s54, -v252
    v_mfma_f32_16x16x32_bf16 v[48:51], v[158:161], v[184:187], v[48:51]
    v_fma_f32 v176, v176, s54, -v252
    v_exp_f32 v164, v164
    v_mfma_f32_16x16x32_bf16 v[60:63], v[158:161], v[188:191], v[60:63]
    s_waitcnt lgkmcnt(2)
    v_exp_f32 v165, v165
    v_mfma_f32_16x16x32_bf16 v[40:43], v[128:131], v[180:183], v[40:43]
    v_exp_f32 v166, v166
    v_mfma_f32_16x16x32_bf16 v[52:55], v[128:131], v[184:187], v[52:55]
    v_cvt_pk_bf16_f32 v164, v164, v165
    v_exp_f32 v167, v167
    v_mfma_f32_16x16x32_bf16 v[64:67], v[128:131], v[188:191], v[64:67]
    s_waitcnt lgkmcnt(1)
    v_exp_f32 v168, v168
    v_mfma_f32_16x16x32_bf16 v[208:211], a[80:83], v[220:223], v[208:211]
    v_cvt_pk_bf16_f32 v165, v166, v167
    v_exp_f32 v169, v169
    v_mfma_f32_16x16x32_bf16 v[212:215], a[104:107], v[220:223], v[212:215]
    v_exp_f32 v170, v170
    v_mfma_f32_16x16x32_bf16 v[216:219], a[120:123], v[232:235], 0
    ds_read_b128 v[232:235], v7 offset:5120
    v_cvt_pk_bf16_f32 v166, v168, v169
    v_mfma_f32_16x16x32_bf16 v[216:219], a[124:127], v[236:239], v[216:219]
    ds_read_b128 v[236:239], v7 offset:19200
    v_exp_f32 v171, v171
    v_mfma_f32_16x16x32_bf16 v[216:219], a[128:131], v[220:223], v[216:219]
    s_waitcnt lgkmcnt(2)
    ds_read_b128 v[220:223], v7 offset:20224
    v_exp_f32 v172, v172
    v_mfma_f32_16x16x32_bf16 v[216:219], a[132:135], v[224:227], v[216:219]
    v_cvt_pk_bf16_f32 v167, v170, v171
    v_exp_f32 v173, v173
    v_mfma_f32_16x16x32_bf16 v[216:219], a[136:139], v[228:231], v[216:219]
    v_exp_f32 v174, v174
    v_mfma_f32_16x16x32_bf16 v[212:215], a[108:111], v[224:227], v[212:215]
    s_waitcnt lgkmcnt(2)
    v_cvt_pk_bf16_f32 v168, v172, v173
    v_exp_f32 v175, v175
    v_mfma_f32_16x16x32_bf16 v[216:219], a[140:143], v[232:235], v[216:219]
    v_exp_f32 v176, v176
    v_mfma_f32_16x16x32_bf16 v[212:215], a[112:115], v[228:231], v[212:215]
    v_cvt_pk_bf16_f32 v169, v174, v175
    v_mov_b32 v171, 0
    v_mfma_f32_16x16x32_bf16 v[212:215], a[116:119], v[232:235], v[212:215]
    v_cvt_pk_bf16_f32 v170, v176, 0
    v_cndmask_b32 v244, v245, v244, vcc
    v_mfma_f32_16x16x32_bf16 v[208:211], a[84:87], v[224:227], v[208:211]
    ds_read_b128 v[224:227], v7 offset:23296
    v_cvt_pk_bf16_f32 v162, v216, v217
    v_mfma_f32_16x16x32_bf16 v[208:211], a[88:91], v[228:231], v[208:211]
    ds_read_b128 v[228:231], v7 offset:25344
    v_cvt_pk_bf16_f32 v163, v218, v219
    v_mfma_f32_16x16x32_bf16 v[208:211], a[92:95], v[232:235], v[208:211]
    s_waitcnt lgkmcnt(3)
    ds_read_b128 v[232:235], v7 offset:26368
    v_cvt_pk_bf16_f32 v160, v212, v213
    v_mfma_f32_16x16x32_bf16 v[32:35], a[216:219], v[236:239], v[32:35]
    s_waitcnt lgkmcnt(3)
    v_cvt_pk_bf16_f32 v161, v214, v215
    v_mfma_f32_16x16x32_bf16 v[32:35], a[220:223], v[220:223], v[32:35]
    s_nop 0
    v_cvt_pk_bf16_f32 v158, v208, v209
    v_cvt_pk_bf16_f32 v159, v210, v211
    v_mfma_f32_16x16x32_bf16 v[36:39], a[228:231], v[236:239], v[36:39]
    s_nop 0
    v_mfma_f32_16x16x32_bf16 v[180:183], v[104:107], v[158:161], 0
    v_mfma_f32_16x16x32_bf16 v[184:187], v[110:113], v[158:161], 0
    v_mfma_f32_16x16x32_bf16 v[188:191], v[116:119], v[158:161], 0
    v_mfma_f32_16x16x32_bf16 v[192:195], v[122:125], v[158:161], v[0:3]
    s_nop 2
    v_mfma_f32_16x16x16_bf16 v[180:183], v[108:109], v[162:163], v[180:183]
    v_mfma_f32_16x16x16_bf16 v[184:187], v[114:115], v[162:163], v[184:187]
    v_mfma_f32_16x16x16_bf16 v[188:191], v[120:121], v[162:163], v[188:191]
    v_mfma_f32_16x16x16_bf16 v[192:195], v[126:127], v[162:163], v[192:195]
    s_waitcnt lgkmcnt(2)
    v_mfma_f32_16x16x32_bf16 v[32:35], a[224:227], v[224:227], v[32:35]
    v_mfma_f32_16x16x32_bf16 v[36:39], a[232:235], v[220:223], v[36:39]
    s_nop 1
    v_max3_f32 v254, v180, v181, v182
    v_mfma_f32_16x16x32_bf16 v[36:39], a[236:239], v[224:227], v[36:39]
    v_max3_f32 v255, v183, v184, v185
    v_max3_f32 v254, v254, v186, v187
    v_mfma_f32_16x16x32_bf16 v[40:43], a[240:243], v[236:239], v[40:43]
    ds_read_b128 v[236:239], v7 offset:29440
    v_cvt_pk_bf16_f32 v32, v32, v33
    v_mfma_f32_16x16x32_bf16 v[40:43], a[244:247], v[220:223], v[40:43]
    ds_read_b128 v[220:223], v7 offset:31488
    v_cvt_pk_bf16_f32 v33, v34, v35
    v_mfma_f32_16x16x32_bf16 v[40:43], a[248:251], v[224:227], v[40:43]
    s_waitcnt lgkmcnt(3)
    ds_write_b64 v12, v[32:33] offset:37632
    v_mfma_f32_16x16x32_bf16 v[44:47], a[216:219], v[228:231], v[44:47]
    s_waitcnt lgkmcnt(3)
    ds_read_b128 v[224:227], v7 offset:32512
    v_cvt_pk_bf16_f32 v36, v36, v37
    v_mfma_f32_16x16x32_bf16 v[44:47], a[220:223], v[232:235], v[44:47]
    v_cvt_pk_bf16_f32 v37, v38, v39
    v_cvt_pk_bf16_f32 v40, v40, v41
    v_mfma_f32_16x16x32_bf16 v[48:51], a[228:231], v[228:231], v[48:51]
    s_waitcnt lgkmcnt(3)
    v_cvt_pk_bf16_f32 v41, v42, v43
    ds_write_b64 v12, v[36:37] offset:37664
    v_mfma_f32_16x16x32_bf16 v[44:47], a[224:227], v[236:239], v[44:47]
    v_max3_f32 v255, v255, v188, v189
    v_max3_f32 v254, v254, v190, v191
    v_mfma_f32_16x16x32_bf16 v[48:51], a[232:235], v[232:235], v[48:51]
    v_max3_f32 v254, v254, v255, v192
    v_mov_b32 v255, v254
    v_mfma_f32_16x16x32_bf16 v[48:51], a[236:239], v[236:239], v[48:51]
    ds_write_b64 v12, v[40:41] offset:37696
    v_mfma_f32_16x16x32_bf16 v[52:55], a[240:243], v[228:231], v[52:55]
    ds_read_b128 v[228:231], v7 offset:35584
    v_cvt_pk_bf16_f32 v44, v44, v45
    v_mfma_f32_16x16x32_bf16 v[52:55], a[244:247], v[232:235], v[52:55]
    ds_read_b128 v[232:235], v7 offset:0
    v_cvt_pk_bf16_f32 v45, v46, v47
    v_mfma_f32_16x16x32_bf16 v[52:55], a[248:251], v[236:239], v[52:55]
    s_waitcnt lgkmcnt(6)
    ds_read_b128 v[236:239], v7 offset:1024
    v_cvt_pk_bf16_f32 v48, v48, v49
    v_mfma_f32_16x16x32_bf16 v[56:59], a[216:219], v[220:223], v[56:59]
    s_waitcnt lgkmcnt(5)
    ds_write_b64 v12, v[44:45] offset:44032
    v_mfma_f32_16x16x32_bf16 v[56:59], a[220:223], v[224:227], v[56:59]
    v_cvt_pk_bf16_f32 v49, v50, v51
    v_cvt_pk_bf16_f32 v52, v52, v53
    v_mfma_f32_16x16x32_bf16 v[60:63], a[228:231], v[220:223], v[60:63]
    s_waitcnt lgkmcnt(3)
    v_cvt_pk_bf16_f32 v53, v54, v55
    v_permlane16_swap_b32 v254, v255
    v_mfma_f32_16x16x32_bf16 v[56:59], a[224:227], v[228:231], v[56:59]
    ds_write_b64 v12, v[48:49] offset:44064
    v_mfma_f32_16x16x32_bf16 v[60:63], a[232:235], v[224:227], v[60:63]
    v_max_f32 v254, v254, v255
    v_mov_b32 v255, v254
    v_mfma_f32_16x16x32_bf16 v[60:63], a[236:239], v[228:231], v[60:63]
    s_nop 0
    v_permlane32_swap_b32 v254, v255
    v_mfma_f32_16x16x32_bf16 v[64:67], a[240:243], v[220:223], v[64:67]
    ds_read_b128 v[220:223], v7 offset:2048
    v_cvt_pk_bf16_f32 v56, v56, v57
    v_mfma_f32_16x16x32_bf16 v[64:67], a[244:247], v[224:227], v[64:67]
    ds_write_b64 v12, v[52:53] offset:44096
    v_mfma_f32_16x16x32_bf16 v[64:67], a[248:251], v[228:231], v[64:67]
    s_waitcnt lgkmcnt(5)
    ds_read_b128 v[224:227], v7 offset:3072
    v_cvt_pk_bf16_f32 v57, v58, v59
    v_mfma_f32_16x16x32_bf16 v[196:199], v[232:235], a[144:147], 0
    s_waitcnt lgkmcnt(5)
    ds_read_b128 v[228:231], v7 offset:4096
    v_cvt_pk_bf16_f32 v60, v60, v61
    v_mfma_f32_16x16x32_bf16 v[196:199], v[236:239], a[148:151], v[196:199]
    ds_read_b64_tr_b16 v[58:59], v18 offset:7744
    v_cvt_pk_bf16_f32 v61, v62, v63
    v_mfma_f32_16x16x32_bf16 v[200:203], v[232:235], a[168:171], 0
    s_waitcnt lgkmcnt(4)
    ds_write_b64 v12, v[56:57] offset:50432
    v_mfma_f32_16x16x32_bf16 v[196:199], v[220:223], a[152:155], v[196:199]
    ds_read_b64_tr_b16 v[62:63], v18 offset:7712
    ds_read_b64_tr_b16 v[56:57], v18 offset:3136
    v_mfma_f32_16x16x32_bf16 v[200:203], v[236:239], a[172:175], v[200:203]
    v_cvt_pk_bf16_f32 v64, v64, v65
    v_cvt_pk_bf16_f32 v65, v66, v67
    v_mfma_f32_16x16x32_bf16 v[200:203], v[220:223], a[176:179], v[200:203]
    ds_read_b64_tr_b16 v[66:67], v18 offset:7680
    ds_write_b64 v12, v[60:61] offset:50464
    v_mfma_f32_16x16x32_bf16 v[204:207], v[232:235], a[192:195], 0
    ds_read_b128 v[232:235], v7 offset:5120
    v_max_f32 v254, v254, v255
    v_mfma_f32_16x16x32_bf16 v[204:207], v[236:239], a[196:199], v[204:207]
    ds_read_b128 v[236:239], v7 offset:6144
    v_mul_f32 v254, s54, v254
    v_mfma_f32_16x16x32_bf16 v[204:207], v[220:223], a[200:203], v[204:207]
    s_waitcnt lgkmcnt(9)
    ds_read_b128 v[220:223], v7 offset:7168
    ds_write_b64 v12, v[64:65] offset:50496
    v_mfma_f32_16x16x32_bf16 v[204:207], v[224:227], a[204:207], v[204:207]
    s_waitcnt lgkmcnt(10)
    v_fma_f32 v180, v180, s54, -v254
    v_fma_f32 v181, v181, s54, -v254
    v_mfma_f32_16x16x32_bf16 v[204:207], v[228:231], a[208:211], v[204:207]
    ds_read_b64_tr_b16 v[64:65], v18 offset:3072
    ds_read_b64_tr_b16 v[60:61], v18 offset:3104
    v_mfma_f32_16x16x32_bf16 v[200:203], v[224:227], a[180:183], v[200:203]
    s_waitcnt lgkmcnt(5)
    v_fma_f32 v182, v182, s54, -v254
    v_fma_f32 v183, v183, s54, -v254
    v_mfma_f32_16x16x32_bf16 v[204:207], v[232:235], a[212:215], v[204:207]
    v_fma_f32 v184, v184, s54, -v254
    v_fma_f32 v185, v185, s54, -v254
    v_mfma_f32_16x16x32_bf16 v[200:203], v[228:231], a[184:187], v[200:203]
    v_fma_f32 v186, v186, s54, -v254
    v_fma_f32 v187, v187, s54, -v254
    v_mfma_f32_16x16x32_bf16 v[200:203], v[232:235], a[188:191], v[200:203]
    v_fma_f32 v188, v188, s54, -v254
    v_fma_f32 v189, v189, s54, -v254
    v_mfma_f32_16x16x32_bf16 v[196:199], v[224:227], a[156:159], v[196:199]
    s_waitcnt lgkmcnt(2)
    s_barrier
    v_mfma_f32_16x16x32_bf16 v[196:199], v[228:231], a[160:163], v[196:199]
    ds_read_b128 v[32:35], v13 offset:37632
    v_cvt_pk_bf16_f32 v144, v204, v205
    v_mfma_f32_16x16x32_bf16 v[196:199], v[232:235], a[164:167], v[196:199]
    ds_read_b128 v[36:39], v13 offset:37760
    v_cvt_pk_bf16_f32 v136, v200, v201
    v_mfma_f32_16x16x32_bf16 v[208:211], v[236:239], a[144:147], 0
    ds_read_b128 v[40:43], v13 offset:37888
    v_cvt_pk_bf16_f32 v137, v202, v203
    v_mfma_f32_16x16x32_bf16 v[208:211], v[220:223], a[148:151], v[208:211]
    ds_read_b128 v[44:47], v13 offset:38032
    v_cvt_pk_bf16_f32 v145, v206, v207
    v_mfma_f32_16x16x32_bf16 v[212:215], v[236:239], a[168:171], 0
    ds_read_b128 v[48:51], v13 offset:38160
    v_cvt_pk_bf16_f32 v128, v196, v197
    v_mfma_f32_16x16x32_bf16 v[212:215], v[220:223], a[172:175], v[212:215]
    ds_read_b128 v[52:55], v13 offset:38288
    v_cvt_pk_bf16_f32 v129, v198, v199
    v_mfma_f32_16x16x32_bf16 v[216:219], v[236:239], a[192:195], 0
    s_waitcnt lgkmcnt(5)
    buffer_store_dwordx4 v[32:35], v14, s[40:43], s90 offen offset:0 sc1
    v_mfma_f32_16x16x32_bf16 v[216:219], v[220:223], a[196:199], v[216:219]
    ds_read_b128 v[224:227], v7 offset:8192
    v_fma_f32 v190, v190, s54, -v254
    v_mfma_f32_16x16x32_bf16 v[172:175], a[252:255], v[164:167], 0
    ds_read_b128 v[228:231], v7 offset:9216
    v_fma_f32 v191, v191, s54, -v254
    v_mfma_f32_16x16x32_bf16 v[172:175], a[252:255], v[168:171], v[172:175]
    s_waitcnt lgkmcnt(6)
    ds_read_b128 v[232:235], v7 offset:10240
    v_fma_f32 v192, v192, s54, -v254
    buffer_store_dwordx4 v[36:39], v14, s[40:43], s90 offen offset:128 sc1
    ds_read_b128 v[236:239], v7 offset:11264
    v_exp_f32 v180, v180
    v_exp_f32 v181, v181
    v_exp_f32 v182, v182
    s_waitcnt lgkmcnt(3)
    v_mfma_f32_16x16x32_bf16 v[208:211], v[224:227], a[152:155], v[208:211]
    ds_read_b128 v[220:223], v7 offset:12288
    v_cvt_pk_bf16_f32 v180, v180, v181
    v_mfma_f32_16x16x32_bf16 v[212:215], v[224:227], a[176:179], v[212:215]
    buffer_store_dwordx4 v[40:43], v14, s[40:43], s90 offen offset:256 sc1
    v_mfma_f32_16x16x32_bf16 v[216:219], v[224:227], a[200:203], v[216:219]
    s_waitcnt lgkmcnt(3)
    ds_read_b128 v[224:227], v7 offset:13312
    v_exp_f32 v183, v183
    v_mfma_f32_16x16x32_bf16 v[216:219], v[228:231], a[204:207], v[216:219]
    s_waitcnt lgkmcnt(3)
    ds_read_b64_tr_b16 v[40:41], v18 offset:0
    ds_read_b64_tr_b16 v[42:43], v18 offset:1536
    v_mfma_f32_16x16x32_bf16 v[216:219], v[232:235], a[208:211], v[216:219]
    s_waitcnt lgkmcnt(4)
    ds_read_b64_tr_b16 v[36:37], v18 offset:32
    ds_read_b64_tr_b16 v[38:39], v18 offset:1568
    v_mfma_f32_16x16x32_bf16 v[216:219], v[236:239], a[212:215], v[216:219]
    buffer_store_dwordx4 v[44:47], v15, s[40:43], s90 offen offset:384 sc1
    v_mfma_f32_16x16x32_bf16 v[212:215], v[228:231], a[180:183], v[212:215]
    s_nop 0
    ds_read_b64_tr_b16 v[44:45], v18 offset:4672
    ds_read_b64_tr_b16 v[46:47], v18 offset:6208
    v_mfma_f32_16x16x32_bf16 v[212:215], v[232:235], a[184:187], v[212:215]
    ds_read_b64_tr_b16 v[32:33], v18 offset:64
    ds_read_b64_tr_b16 v[34:35], v18 offset:1600
    v_mfma_f32_16x16x32_bf16 v[212:215], v[236:239], a[188:191], v[212:215]
    v_exp_f32 v184, v184
    v_mfma_f32_16x16x32_bf16 v[208:211], v[228:231], a[156:159], v[208:211]
    buffer_store_dwordx4 v[48:51], v15, s[40:43], s90 offen offset:512 sc1
    v_mfma_f32_16x16x32_bf16 v[208:211], v[232:235], a[160:163], v[208:211]
    ds_read_b128 v[228:231], v7 offset:14336
    v_cvt_pk_bf16_f32 v181, v182, v183
    v_mfma_f32_16x16x32_bf16 v[208:211], v[236:239], a[164:167], v[208:211]
    s_waitcnt lgkmcnt(10)
    ds_read_b128 v[232:235], v7 offset:15360
    v_exp_f32 v185, v185
    v_mfma_f32_16x16x32_bf16 v[196:199], v[220:223], a[144:147], 0
    s_waitcnt lgkmcnt(10)
    ds_read_b128 v[236:239], v7 offset:16384
    buffer_store_dwordx4 v[52:55], v15, s[40:43], s90 offen offset:640 sc1
    v_mfma_f32_16x16x32_bf16 v[196:199], v[224:227], a[148:151], v[196:199]
    s_nop 0
    ds_read_b64_tr_b16 v[52:53], v18 offset:4608
    ds_read_b64_tr_b16 v[54:55], v18 offset:6144
    v_mfma_f32_16x16x32_bf16 v[200:203], v[220:223], a[168:171], 0
    s_waitcnt lgkmcnt(4)
    ds_read_b64_tr_b16 v[48:49], v18 offset:4640
    ds_read_b64_tr_b16 v[50:51], v18 offset:6176
    v_mfma_f32_16x16x32_bf16 v[196:199], v[228:231], a[152:155], v[196:199]
    v_exp_f32 v186, v186
    v_mfma_f32_16x16x32_bf16 v[200:203], v[224:227], a[172:175], v[200:203]
    v_cvt_pk_bf16_f32 v182, v184, v185
    v_exp_f32 v187, v187
    v_mfma_f32_16x16x32_bf16 v[200:203], v[228:231], a[176:179], v[200:203]
    v_exp_f32 v188, v188
    v_mfma_f32_16x16x32_bf16 v[204:207], v[220:223], a[192:195], 0
    ds_read_b128 v[220:223], v7 offset:17408
    v_cvt_pk_bf16_f32 v183, v186, v187
    v_mfma_f32_16x16x32_bf16 v[204:207], v[224:227], a[196:199], v[204:207]
    ds_read_b128 v[224:227], v7 offset:6144
    v_exp_f32 v189, v189
    v_mfma_f32_16x16x32_bf16 v[204:207], v[228:231], a[200:203], v[204:207]
    s_waitcnt lgkmcnt(7)
    ds_read_b128 v[228:231], v7 offset:7168
    v_exp_f32 v190, v190
    v_mfma_f32_16x16x32_bf16 v[204:207], v[232:235], a[204:207], v[204:207]
    s_waitcnt lgkmcnt(7)
    v_cvt_pk_bf16_f32 v184, v188, v189
    v_exp_f32 v191, v191
    v_mfma_f32_16x16x32_bf16 v[204:207], v[236:239], a[208:211], v[204:207]
    v_exp_f32 v192, v192
    v_mfma_f32_16x16x32_bf16 v[200:203], v[232:235], a[180:183], v[200:203]
    s_waitcnt lgkmcnt(2)
    v_cvt_pk_bf16_f32 v185, v190, v191
    v_mov_b32 v187, 0
    v_mfma_f32_16x16x32_bf16 v[204:207], v[220:223], a[212:215], v[204:207]
    v_cvt_pk_bf16_f32 v186, v192, 0
    v_cvt_pk_bf16_f32 v130, v208, v209
    v_mfma_f32_16x16x32_bf16 v[200:203], v[236:239], a[184:187], v[200:203]
    v_cvt_pk_bf16_f32 v131, v210, v211
    v_cvt_pk_bf16_f32 v138, v212, v213
    v_mfma_f32_16x16x32_bf16 v[200:203], v[220:223], a[188:191], v[200:203]
    v_cvt_pk_bf16_f32 v139, v214, v215
    v_cvt_pk_bf16_f32 v146, v216, v217
    v_mfma_f32_16x16x32_bf16 v[196:199], v[232:235], a[156:159], v[196:199]
    ds_read_b128 v[232:235], v7 offset:8192
    v_cvt_pk_bf16_f32 v147, v218, v219
    v_mfma_f32_16x16x32_bf16 v[196:199], v[236:239], a[160:163], v[196:199]
    ds_read_b128 v[236:239], v7 offset:9216
    v_cvt_pk_bf16_f32 v148, v204, v205
    v_mfma_f32_16x16x32_bf16 v[196:199], v[220:223], a[164:167], v[196:199]
    s_waitcnt lgkmcnt(3)
    ds_read_b128 v[220:223], v7 offset:10240
    v_cvt_pk_bf16_f32 v140, v200, v201
    v_mfma_f32_16x16x32_bf16 v[208:211], a[72:75], v[224:227], 0
    s_waitcnt lgkmcnt(3)
    v_cvt_pk_bf16_f32 v141, v202, v203
    v_cvt_pk_bf16_f32 v149, v206, v207
    v_mfma_f32_16x16x32_bf16 v[208:211], a[76:79], v[228:231], v[208:211]
    v_cvt_pk_bf16_f32 v132, v196, v197
    v_cvt_pk_bf16_f32 v133, v198, v199
    v_mfma_f32_16x16x32_bf16 v[212:215], a[96:99], v[224:227], 0
    v_rcp_f32 v172, v172
    v_mfma_f32_16x16x32_bf16 v[212:215], a[100:103], v[228:231], v[212:215]
    s_waitcnt lgkmcnt(2)
    v_mfma_f32_16x16x32_bf16 v[208:211], a[80:83], v[232:235], v[208:211]
    v_mfma_f32_16x16x32_bf16 v[212:215], a[104:107], v[232:235], v[212:215]
    v_mfma_f32_16x16x32_bf16 v[216:219], a[120:123], v[224:227], 0
    ds_read_b128 v[224:227], v7 offset:11264
    v_mfma_f32_16x16x32_bf16 v[216:219], a[124:127], v[228:231], v[216:219]
    ds_read_b128 v[228:231], v7 offset:12288
    v_mfma_f32_16x16x32_bf16 v[216:219], a[128:131], v[232:235], v[216:219]
    s_waitcnt lgkmcnt(3)
    ds_read_b128 v[232:235], v7 offset:13312
    v_mfma_f32_16x16x32_bf16 v[216:219], a[132:135], v[236:239], v[216:219]
    s_waitcnt lgkmcnt(3)
    v_mfma_f32_16x16x32_bf16 v[216:219], a[136:139], v[220:223], v[216:219]
    v_mfma_f32_16x16x32_bf16 v[212:215], a[108:111], v[236:239], v[212:215]
    v_mfma_f32_16x16x32_bf16 v[212:215], a[112:115], v[220:223], v[212:215]
    s_waitcnt lgkmcnt(2)
    v_mfma_f32_16x16x32_bf16 v[216:219], a[140:143], v[224:227], v[216:219]
    v_mfma_f32_16x16x32_bf16 v[212:215], a[116:119], v[224:227], v[212:215]
    v_mfma_f32_16x16x32_bf16 v[208:211], a[84:87], v[236:239], v[208:211]
    ds_read_b128 v[236:239], v7 offset:14336
    v_mfma_f32_16x16x32_bf16 v[208:211], a[88:91], v[220:223], v[208:211]
    ds_read_b128 v[220:223], v7 offset:15360
    v_mfma_f32_16x16x32_bf16 v[208:211], a[92:95], v[224:227], v[208:211]
    ds_read_b128 v[224:227], v7 offset:16384
    v_mfma_f32_16x16x32_bf16 v[196:199], v[128:131], v[164:167], 0
    s_nop 0
    v_cvt_pk_bf16_f32 v160, v212, v213
    v_cvt_pk_bf16_f32 v161, v214, v215
    v_mfma_f32_16x16x32_bf16 v[196:199], v[132:135], v[168:171], v[196:199]
    v_cvt_pk_bf16_f32 v162, v216, v217
    v_cvt_pk_bf16_f32 v163, v218, v219
    v_mfma_f32_16x16x32_bf16 v[200:203], v[136:139], v[164:167], 0
    v_cvt_pk_bf16_f32 v158, v208, v209
    v_cvt_pk_bf16_f32 v159, v210, v211
    v_mfma_f32_16x16x32_bf16 v[200:203], v[140:143], v[168:171], v[200:203]
    s_nop 1
    v_mul_f32 v196, v172, v196
    v_mfma_f32_16x16x32_bf16 v[204:207], v[144:147], v[164:167], 0
    v_mul_f32 v197, v172, v197
    v_cvt_pk_bf16_f32 v196, v196, v197
    v_mfma_f32_16x16x32_bf16 v[204:207], v[148:151], v[168:171], v[204:207]
    v_mul_f32 v198, v172, v198
    v_mul_f32 v199, v172, v199
    v_mfma_f32_16x16x32_bf16 v[164:167], v[104:107], v[158:161], 0
    v_cvt_pk_bf16_f32 v197, v198, v199
    v_mul_f32 v200, v172, v200
    v_mfma_f32_16x16x32_bf16 v[168:171], v[110:113], v[158:161], 0
    v_mul_f32 v201, v172, v201
    v_cvt_pk_bf16_f32 v198, v200, v201
    v_mfma_f32_16x16x32_bf16 v[176:179], v[122:125], v[158:161], v[0:3]
    v_mul_f32 v202, v172, v202
    v_mul_f32 v203, v172, v203
    v_mfma_f32_16x16x16_bf16 v[164:167], v[108:109], v[162:163], v[164:167]
    v_cvt_pk_bf16_f32 v199, v202, v203
    v_mul_f32 v204, v172, v204
    v_mfma_f32_16x16x16_bf16 v[168:171], v[114:115], v[162:163], v[168:171]
    s_mov_b64 exec, s[80:81]
    ds_write_b128 v8, v[196:199] offset:56832
    s_mov_b64 exec, -1
    v_mfma_f32_16x16x16_bf16 v[176:179], v[126:127], v[162:163], v[176:179]
    v_mul_f32 v205, v172, v205
    v_cvt_pk_bf16_f32 v200, v204, v205
    v_mfma_f32_16x16x32_bf16 v[188:191], a[252:255], v[180:183], 0
    v_mul_f32 v206, v172, v206
    v_mul_f32 v207, v172, v207
    v_mfma_f32_16x16x32_bf16 v[172:175], v[116:119], v[158:161], 0
    v_cvt_pk_bf16_f32 v201, v206, v207
    s_mov_b64 exec, s[80:81]
    ds_write_b64 v9, v[200:201] offset:56832
    s_mov_b64 exec, -1
    v_mfma_f32_16x16x32_bf16 v[188:191], a[252:255], v[184:187], v[188:191]
    v_max3_f32 v252, v164, v165, v166
    v_max3_f32 v253, v167, v168, v169
    v_mfma_f32_16x16x32_bf16 v[208:211], v[128:131], v[180:183], 0
    v_max3_f32 v252, v252, v170, v171
    v_mfma_f32_16x16x16_bf16 v[172:175], v[120:121], v[162:163], v[172:175]
    v_mfma_f32_16x16x32_bf16 v[208:211], v[132:135], v[184:187], v[208:211]
    s_nop 1
    v_rcp_f32 v188, v188
    v_mfma_f32_16x16x32_bf16 v[212:215], v[136:139], v[180:183], 0
    v_mfma_f32_16x16x32_bf16 v[212:215], v[140:143], v[184:187], v[212:215]
    s_nop 1
    v_max3_f32 v253, v253, v172, v173
    v_mfma_f32_16x16x32_bf16 v[216:219], v[144:147], v[180:183], 0
    v_mul_f32 v208, v188, v208
    v_mul_f32 v209, v188, v209
    v_mfma_f32_16x16x32_bf16 v[216:219], v[148:151], v[184:187], v[216:219]
    s_waitcnt lgkmcnt(6)
    v_cvt_pk_bf16_f32 v208, v208, v209
    v_mul_f32 v210, v188, v210
    v_mfma_f32_16x16x32_bf16 v[196:199], a[72:75], v[228:231], 0
    s_waitcnt lgkmcnt(5)
    v_mul_f32 v211, v188, v211
    v_cvt_pk_bf16_f32 v209, v210, v211
    v_mfma_f32_16x16x32_bf16 v[196:199], a[76:79], v[232:235], v[196:199]
    s_waitcnt lgkmcnt(4)
    v_mul_f32 v212, v188, v212
    v_mul_f32 v213, v188, v213
    v_mfma_f32_16x16x32_bf16 v[196:199], a[80:83], v[236:239], v[196:199]
    v_cvt_pk_bf16_f32 v210, v212, v213
    v_mul_f32 v214, v188, v214
    v_mfma_f32_16x16x32_bf16 v[200:203], a[96:99], v[228:231], 0
    v_mul_f32 v215, v188, v215
    v_cvt_pk_bf16_f32 v211, v214, v215
    v_mfma_f32_16x16x32_bf16 v[200:203], a[100:103], v[232:235], v[200:203]
    ds_write_b128 v8, v[208:211] offset:19200
    v_mfma_f32_16x16x32_bf16 v[200:203], a[104:107], v[236:239], v[200:203]
    v_mul_f32 v216, v188, v216
    v_mul_f32 v217, v188, v217
    v_mfma_f32_16x16x32_bf16 v[204:207], a[120:123], v[228:231], 0
    ds_read_b128 v[228:231], v7 offset:17408
    v_cvt_pk_bf16_f32 v212, v216, v217
    v_mfma_f32_16x16x32_bf16 v[204:207], a[124:127], v[232:235], v[204:207]
    v_mul_f32 v218, v188, v218
    v_mul_f32 v219, v188, v219
    v_mfma_f32_16x16x32_bf16 v[204:207], a[128:131], v[236:239], v[204:207]
    s_waitcnt lgkmcnt(5)
    v_cvt_pk_bf16_f32 v213, v218, v219
    v_max3_f32 v252, v252, v174, v175
    v_mfma_f32_16x16x32_bf16 v[204:207], a[132:135], v[220:223], v[204:207]
    s_waitcnt lgkmcnt(4)
    ds_write_b64 v9, v[212:213] offset:19200
    v_mfma_f32_16x16x32_bf16 v[204:207], a[136:139], v[224:227], v[204:207]
    v_max3_f32 v252, v252, v253, v176
    v_mov_b32 v253, v252
    v_mfma_f32_16x16x32_bf16 v[200:203], a[108:111], v[220:223], v[200:203]
    s_nop 0
    v_permlane16_swap_b32 v252, v253
    s_waitcnt lgkmcnt(1)
    v_mfma_f32_16x16x32_bf16 v[204:207], a[140:143], v[228:231], v[204:207]
    v_max_f32 v252, v252, v253
    v_mov_b32 v253, v252
    v_mfma_f32_16x16x32_bf16 v[200:203], a[112:115], v[224:227], v[200:203]
    s_nop 0
    v_permlane32_swap_b32 v252, v253
    v_mfma_f32_16x16x32_bf16 v[200:203], a[116:119], v[228:231], v[200:203]
    v_max_f32 v252, v252, v253
    v_mul_f32 v252, s54, v252
    v_mfma_f32_16x16x32_bf16 v[196:199], a[84:87], v[220:223], v[196:199]
    s_waitcnt lgkmcnt(0)
    s_barrier
    v_mfma_f32_16x16x32_bf16 v[196:199], a[88:91], v[224:227], v[196:199]
    ds_read_b128 v[232:235], v7 offset:56832
    v_cvt_pk_bf16_f32 v162, v204, v205
    v_mfma_f32_16x16x32_bf16 v[196:199], a[92:95], v[228:231], v[196:199]
    ds_read_b128 v[236:239], v7 offset:57856
    v_cvt_pk_bf16_f32 v160, v200, v201
    v_cvt_pk_bf16_f32 v161, v202, v203
    v_cvt_pk_bf16_f32 v163, v206, v207
    v_fma_f32 v164, v164, s54, -v252
    v_fma_f32 v165, v165, s54, -v252
    v_fma_f32 v166, v166, s54, -v252
    v_fma_f32 v167, v167, s54, -v252
    v_cvt_pk_bf16_f32 v158, v196, v197
    v_cvt_pk_bf16_f32 v159, v198, v199
    v_fma_f32 v168, v168, s54, -v252
    v_fma_f32 v169, v169, s54, -v252
    v_mfma_f32_16x16x32_bf16 v[180:183], v[104:107], v[158:161], 0
    ds_read_b128 v[220:223], v7 offset:60928
    v_fma_f32 v170, v170, s54, -v252
    v_mfma_f32_16x16x32_bf16 v[184:187], v[110:113], v[158:161], 0
    ds_read_b128 v[224:227], v7 offset:61952
    v_fma_f32 v171, v171, s54, -v252
    v_mfma_f32_16x16x32_bf16 v[188:191], v[116:119], v[158:161], 0
    ds_read_b128 v[228:231], v7 offset:59904
    v_fma_f32 v172, v172, s54, -v252
    v_mfma_f32_16x16x32_bf16 v[192:195], v[122:125], v[158:161], v[0:3]
    v_fma_f32 v173, v173, s54, -v252
    v_fma_f32 v174, v174, s54, -v252
    v_mfma_f32_16x16x16_bf16 v[180:183], v[108:109], v[162:163], v[180:183]
    v_fma_f32 v175, v175, s54, -v252
    v_fma_f32 v176, v176, s54, -v252
    v_mfma_f32_16x16x16_bf16 v[184:187], v[114:115], v[162:163], v[184:187]
    v_exp_f32 v164, v164
    v_mfma_f32_16x16x16_bf16 v[188:191], v[120:121], v[162:163], v[188:191]
    v_exp_f32 v165, v165
    v_mfma_f32_16x16x16_bf16 v[192:195], v[126:127], v[162:163], v[192:195]
    s_waitcnt lgkmcnt(4)
    v_exp_f32 v166, v166
    v_mfma_f32_16x16x32_bf16 v[20:23], a[216:219], v[232:235], v[20:23]
    s_waitcnt lgkmcnt(3)
    v_cvt_pk_bf16_f32 v164, v164, v165
    v_exp_f32 v167, v167
    v_mfma_f32_16x16x32_bf16 v[20:23], a[220:223], v[236:239], v[20:23]
    s_waitcnt lgkmcnt(2)
    v_exp_f32 v168, v168
    v_mfma_f32_16x16x32_bf16 v[20:23], a[224:227], v[220:223], v[20:23]
    v_cvt_pk_bf16_f32 v165, v166, v167
    v_exp_f32 v169, v169
    v_mfma_f32_16x16x32_bf16 v[24:27], a[228:231], v[232:235], v[24:27]
    v_exp_f32 v170, v170
    v_mfma_f32_16x16x32_bf16 v[24:27], a[232:235], v[236:239], v[24:27]
    v_cvt_pk_bf16_f32 v166, v168, v169
    v_exp_f32 v171, v171
    v_mfma_f32_16x16x32_bf16 v[24:27], a[236:239], v[220:223], v[24:27]
    v_exp_f32 v172, v172
    v_mfma_f32_16x16x32_bf16 v[28:31], a[240:243], v[232:235], v[28:31]
    ds_read_b128 v[232:235], v7 offset:58880
    v_cvt_pk_bf16_f32 v167, v170, v171
    v_mfma_f32_16x16x32_bf16 v[28:31], a[244:247], v[236:239], v[28:31]
    ds_read_b128 v[236:239], v7 offset:19200
    v_exp_f32 v173, v173
    v_mfma_f32_16x16x32_bf16 v[28:31], a[248:251], v[220:223], v[28:31]
    s_waitcnt lgkmcnt(3)
    ds_read_b128 v[220:223], v7 offset:20224
    v_exp_f32 v174, v174
    v_mfma_f32_16x16x32_bf16 v[28:31], v[56:59], v[224:227], v[28:31]
    s_waitcnt lgkmcnt(3)
    v_cvt_pk_bf16_f32 v168, v172, v173
    v_exp_f32 v175, v175
    v_mfma_f32_16x16x32_bf16 v[28:31], v[44:47], v[228:231], v[28:31]
    v_exp_f32 v176, v176
    v_mfma_f32_16x16x32_bf16 v[24:27], v[60:63], v[224:227], v[24:27]
    s_waitcnt lgkmcnt(2)
    v_cvt_pk_bf16_f32 v169, v174, v175
    v_mov_b32 v171, 0
    v_mfma_f32_16x16x32_bf16 v[28:31], v[32:35], v[232:235], v[28:31]
    v_cvt_pk_bf16_f32 v170, v176, 0
    v_max3_f32 v254, v180, v181, v182
    v_mfma_f32_16x16x32_bf16 v[24:27], v[48:51], v[228:231], v[24:27]
    v_max3_f32 v255, v183, v184, v185
    v_max3_f32 v254, v254, v186, v187
    v_mfma_f32_16x16x32_bf16 v[24:27], v[36:39], v[232:235], v[24:27]
    v_max3_f32 v255, v255, v188, v189
    v_max3_f32 v254, v254, v190, v191
    v_mfma_f32_16x16x32_bf16 v[20:23], v[64:67], v[224:227], v[20:23]
    ds_read_b128 v[224:227], v7 offset:23296
    v_cvt_pk_bf16_f32 v28, v28, v29
    v_mfma_f32_16x16x32_bf16 v[20:23], v[52:55], v[228:231], v[20:23]
    ds_read_b128 v[228:231], v7 offset:24320
    v_cvt_pk_bf16_f32 v29, v30, v31
    v_mfma_f32_16x16x32_bf16 v[20:23], v[40:43], v[232:235], v[20:23]
    ds_write_b64 v241, v[28:29] offset:64
    v_mfma_f32_16x16x32_bf16 v[172:175], a[252:255], v[164:167], 0
    ds_read_b128 v[232:235], v7 offset:22272
    v_cvt_pk_bf16_f32 v24, v24, v25
    v_mfma_f32_16x16x32_bf16 v[172:175], a[252:255], v[168:171], v[172:175]
    v_cvt_pk_bf16_f32 v25, v26, v27
    v_max3_f32 v254, v254, v255, v192
    v_mfma_f32_16x16x32_bf16 v[208:211], v[128:131], v[164:167], 0
    v_cvt_pk_bf16_f32 v20, v20, v21
    v_cvt_pk_bf16_f32 v21, v22, v23
    v_mfma_f32_16x16x32_bf16 v[208:211], v[132:135], v[168:171], v[208:211]
    ds_write_b64 v241, v[20:21] offset:0
    v_mfma_f32_16x16x32_bf16 v[212:215], v[136:139], v[164:167], 0
    v_rcp_f32 v172, v172
    v_mfma_f32_16x16x32_bf16 v[212:215], v[140:143], v[168:171], v[212:215]
    v_mov_b32 v255, v254
    v_mfma_f32_16x16x32_bf16 v[216:219], v[144:147], v[164:167], 0
    ds_write_b64 v241, v[24:25] offset:32
    v_mfma_f32_16x16x32_bf16 v[216:219], v[148:151], v[168:171], v[216:219]
    s_waitcnt lgkmcnt(7)
    v_mul_f32 v208, v172, v208
    v_mul_f32 v209, v172, v209
    v_mfma_f32_16x16x32_bf16 v[68:71], a[216:219], v[236:239], v[68:71]
    s_waitcnt lgkmcnt(6)
    v_cvt_pk_bf16_f32 v208, v208, v209
    v_mul_f32 v210, v172, v210
    v_mfma_f32_16x16x32_bf16 v[68:71], a[220:223], v[220:223], v[68:71]
    s_waitcnt lgkmcnt(5)
    v_mul_f32 v211, v172, v211
    v_cvt_pk_bf16_f32 v209, v210, v211
    v_mfma_f32_16x16x32_bf16 v[68:71], a[224:227], v[224:227], v[68:71]
    v_mul_f32 v212, v172, v212
    v_mul_f32 v213, v172, v213
    v_mfma_f32_16x16x32_bf16 v[72:75], a[228:231], v[236:239], v[72:75]
    v_cvt_pk_bf16_f32 v210, v212, v213
    v_mul_f32 v214, v172, v214
    v_mfma_f32_16x16x32_bf16 v[72:75], a[232:235], v[220:223], v[72:75]
    v_mul_f32 v215, v172, v215
    v_cvt_pk_bf16_f32 v211, v214, v215
    v_mfma_f32_16x16x32_bf16 v[72:75], a[236:239], v[224:227], v[72:75]
    ds_write_b128 v8, v[208:211] offset:25344
    v_mfma_f32_16x16x32_bf16 v[76:79], a[240:243], v[236:239], v[76:79]
    v_mul_f32 v216, v172, v216
    v_mul_f32 v217, v172, v217
    v_mfma_f32_16x16x32_bf16 v[76:79], a[244:247], v[220:223], v[76:79]
    ds_read_b128 v[236:239], v7 offset:21248
    v_cvt_pk_bf16_f32 v212, v216, v217
    v_mfma_f32_16x16x32_bf16 v[76:79], a[248:251], v[224:227], v[76:79]
    s_waitcnt lgkmcnt(6)
    v_mul_f32 v218, v172, v218
    v_mul_f32 v219, v172, v219
    v_mfma_f32_16x16x32_bf16 v[76:79], v[56:59], v[228:231], v[76:79]
    s_waitcnt lgkmcnt(4)
    v_cvt_pk_bf16_f32 v213, v218, v219
    v_permlane16_swap_b32 v254, v255
    v_mfma_f32_16x16x32_bf16 v[76:79], v[44:47], v[232:235], v[76:79]
    ds_write_b64 v9, v[212:213] offset:25344
    v_mfma_f32_16x16x32_bf16 v[72:75], v[60:63], v[228:231], v[72:75]
    v_max_f32 v254, v254, v255
    v_mov_b32 v255, v254
    v_mfma_f32_16x16x32_bf16 v[72:75], v[48:51], v[232:235], v[72:75]
    s_nop 0
    v_permlane32_swap_b32 v254, v255
    s_waitcnt lgkmcnt(1)
    v_mfma_f32_16x16x32_bf16 v[76:79], v[32:35], v[236:239], v[76:79]
    v_max_f32 v254, v254, v255
    v_mul_f32 v254, s54, v254
    v_mfma_f32_16x16x32_bf16 v[72:75], v[36:39], v[236:239], v[72:75]
    v_fma_f32 v180, v180, s54, -v254
    v_fma_f32 v181, v181, s54, -v254
    v_mfma_f32_16x16x32_bf16 v[68:71], v[64:67], v[228:231], v[68:71]
    v_fma_f32 v182, v182, s54, -v254
    v_fma_f32 v183, v183, s54, -v254
    v_mfma_f32_16x16x32_bf16 v[68:71], v[52:55], v[232:235], v[68:71]
    s_waitcnt lgkmcnt(0)
    s_barrier
    v_mfma_f32_16x16x32_bf16 v[68:71], v[40:43], v[236:239], v[68:71]
    ds_read_b128 v[220:223], v7 offset:25344
    v_cvt_pk_bf16_f32 v72, v72, v73
    v_cvt_pk_bf16_f32 v73, v74, v75
    ds_write_b64 v12, v[72:73] offset:37664
    v_cvt_pk_bf16_f32 v76, v76, v77
    v_cvt_pk_bf16_f32 v77, v78, v79
    v_fma_f32 v184, v184, s54, -v254
    v_fma_f32 v185, v185, s54, -v254
    v_cvt_pk_bf16_f32 v68, v68, v69
    v_cvt_pk_bf16_f32 v69, v70, v71
    v_fma_f32 v186, v186, s54, -v254
    v_fma_f32 v187, v187, s54, -v254
    v_fma_f32 v188, v188, s54, -v254
    v_fma_f32 v189, v189, s54, -v254
    ds_write_b64 v12, v[68:69] offset:37632
    s_waitcnt lgkmcnt(2)
    v_mfma_f32_16x16x32_bf16 v[80:83], a[216:219], v[220:223], v[80:83]
    ds_read_b128 v[224:227], v7 offset:26368
    v_fma_f32 v190, v190, s54, -v254
    v_mfma_f32_16x16x32_bf16 v[84:87], a[228:231], v[220:223], v[84:87]
    ds_read_b128 v[228:231], v7 offset:29440
    v_fma_f32 v191, v191, s54, -v254
    v_mfma_f32_16x16x32_bf16 v[88:91], a[240:243], v[220:223], v[88:91]
    ds_read_b128 v[232:235], v7 offset:30464
    ds_write_b64 v12, v[76:77] offset:37696
    v_fma_f32 v192, v192, s54, -v254
    v_exp_f32 v180, v180
    v_exp_f32 v181, v181
    v_exp_f32 v182, v182
    v_cvt_pk_bf16_f32 v180, v180, v181
    v_exp_f32 v183, v183
    s_waitcnt lgkmcnt(3)
    v_mfma_f32_16x16x32_bf16 v[80:83], a[220:223], v[224:227], v[80:83]
    s_waitcnt lgkmcnt(2)
    ds_read_b128 v[236:239], v7 offset:28416
    v_exp_f32 v184, v184
    v_mfma_f32_16x16x32_bf16 v[80:83], a[224:227], v[228:231], v[80:83]
    ds_read_b128 v[220:223], v7 offset:27392
    v_cvt_pk_bf16_f32 v181, v182, v183
    v_mfma_f32_16x16x32_bf16 v[84:87], a[232:235], v[224:227], v[84:87]
    v_exp_f32 v185, v185
    v_mfma_f32_16x16x32_bf16 v[84:87], a[236:239], v[228:231], v[84:87]
    v_exp_f32 v186, v186
    v_mfma_f32_16x16x32_bf16 v[88:91], a[244:247], v[224:227], v[88:91]
    v_cvt_pk_bf16_f32 v182, v184, v185
    v_exp_f32 v187, v187
    v_mfma_f32_16x16x32_bf16 v[88:91], a[248:251], v[228:231], v[88:91]
    s_waitcnt lgkmcnt(3)
    v_exp_f32 v188, v188
    v_mfma_f32_16x16x32_bf16 v[88:91], v[56:59], v[232:235], v[88:91]
    s_waitcnt lgkmcnt(1)
    v_cvt_pk_bf16_f32 v183, v186, v187
    v_exp_f32 v189, v189
    v_mfma_f32_16x16x32_bf16 v[88:91], v[44:47], v[236:239], v[88:91]
    s_waitcnt lgkmcnt(0)
    v_exp_f32 v190, v190
    v_mfma_f32_16x16x32_bf16 v[88:91], v[32:35], v[220:223], v[88:91]
    v_cvt_pk_bf16_f32 v184, v188, v189
    v_exp_f32 v191, v191
    v_mfma_f32_16x16x32_bf16 v[84:87], v[60:63], v[232:235], v[84:87]
    v_exp_f32 v192, v192
    v_mfma_f32_16x16x32_bf16 v[84:87], v[48:51], v[236:239], v[84:87]
    v_cvt_pk_bf16_f32 v185, v190, v191
    v_mov_b32 v187, 0
    v_mfma_f32_16x16x32_bf16 v[84:87], v[36:39], v[220:223], v[84:87]
    v_cvt_pk_bf16_f32 v186, v192, 0
    v_cvt_pk_bf16_f32 v88, v88, v89
    v_mfma_f32_16x16x32_bf16 v[80:83], v[64:67], v[232:235], v[80:83]
    v_cvt_pk_bf16_f32 v89, v90, v91
    v_mfma_f32_16x16x32_bf16 v[80:83], v[52:55], v[236:239], v[80:83]
    ds_write_b64 v12, v[88:89] offset:44096
    v_mfma_f32_16x16x32_bf16 v[80:83], v[40:43], v[220:223], v[80:83]
    s_nop 0
    v_cvt_pk_bf16_f32 v84, v84, v85
    v_cvt_pk_bf16_f32 v85, v86, v87
    v_mfma_f32_16x16x32_bf16 v[188:191], a[252:255], v[180:183], 0
    v_mfma_f32_16x16x32_bf16 v[188:191], a[252:255], v[184:187], v[188:191]
    v_mfma_f32_16x16x32_bf16 v[196:199], v[128:131], v[180:183], 0
    ds_write_b64 v12, v[84:85] offset:44064
    v_mfma_f32_16x16x32_bf16 v[196:199], v[132:135], v[184:187], v[196:199]
    v_cvt_pk_bf16_f32 v80, v80, v81
    v_cvt_pk_bf16_f32 v81, v82, v83
    v_mfma_f32_16x16x32_bf16 v[200:203], v[136:139], v[180:183], 0
    s_nop 1
    v_rcp_f32 v188, v188
    v_mfma_f32_16x16x32_bf16 v[200:203], v[140:143], v[184:187], v[200:203]
    s_nop 0
    v_mul_f32 v196, v188, v196
    v_mul_f32 v197, v188, v197
    v_mfma_f32_16x16x32_bf16 v[204:207], v[144:147], v[180:183], 0
    ds_write_b64 v12, v[80:81] offset:44032
    v_mfma_f32_16x16x32_bf16 v[204:207], v[148:151], v[184:187], v[204:207]
    v_cvt_pk_bf16_f32 v196, v196, v197
    v_mul_f32 v198, v188, v198
    v_mul_f32 v199, v188, v199
    v_cvt_pk_bf16_f32 v197, v198, v199
    v_mul_f32 v200, v188, v200
    v_mul_f32 v201, v188, v201
    v_cvt_pk_bf16_f32 v198, v200, v201
    v_mul_f32 v202, v188, v202
    v_mul_f32 v203, v188, v203
    v_cvt_pk_bf16_f32 v199, v202, v203
    v_mul_f32 v204, v188, v204
    v_mul_f32 v205, v188, v205
    v_cvt_pk_bf16_f32 v200, v204, v205
    v_mul_f32 v206, v188, v206
    v_mul_f32 v207, v188, v207
    v_cvt_pk_bf16_f32 v201, v206, v207
    ds_write_b128 v8, v[196:199] offset:31488
    ds_write_b64 v9, v[200:201] offset:31488
    s_waitcnt lgkmcnt(0)
    s_barrier
    ds_read_b128 v[164:167], v243 offset:0
    ds_read_b128 v[224:227], v7 offset:31488
    ds_read_b128 v[228:231], v7 offset:32512
    ds_read_b128 v[232:235], v7 offset:35584
    ds_read_b128 v[236:239], v7 offset:36608
    ds_read_b128 v[220:223], v7 offset:34560
    s_waitcnt lgkmcnt(5)
    buffer_store_dwordx4 v[164:167], v244, s[40:43], s53 offen sc1
    s_waitcnt lgkmcnt(4)
    v_mfma_f32_16x16x32_bf16 v[92:95], a[216:219], v[224:227], v[92:95]
    s_waitcnt lgkmcnt(3)
    v_mfma_f32_16x16x32_bf16 v[92:95], a[220:223], v[228:231], v[92:95]
    s_waitcnt lgkmcnt(2)
    v_mfma_f32_16x16x32_bf16 v[92:95], a[224:227], v[232:235], v[92:95]
    v_mfma_f32_16x16x32_bf16 v[96:99], a[228:231], v[224:227], v[96:99]
    v_mfma_f32_16x16x32_bf16 v[96:99], a[232:235], v[228:231], v[96:99]
    v_mfma_f32_16x16x32_bf16 v[96:99], a[236:239], v[232:235], v[96:99]
    v_mfma_f32_16x16x32_bf16 v[100:103], a[240:243], v[224:227], v[100:103]
    ds_read_b128 v[224:227], v7 offset:33536
    v_mfma_f32_16x16x32_bf16 v[100:103], a[244:247], v[228:231], v[100:103]
    v_mfma_f32_16x16x32_bf16 v[100:103], a[248:251], v[232:235], v[100:103]
    s_waitcnt lgkmcnt(2)
    v_mfma_f32_16x16x32_bf16 v[100:103], v[56:59], v[236:239], v[100:103]
    s_waitcnt lgkmcnt(1)
    v_mfma_f32_16x16x32_bf16 v[100:103], v[44:47], v[220:223], v[100:103]
    v_mfma_f32_16x16x32_bf16 v[96:99], v[60:63], v[236:239], v[96:99]
    v_mfma_f32_16x16x32_bf16 v[96:99], v[48:51], v[220:223], v[96:99]
    s_waitcnt lgkmcnt(0)
    v_mfma_f32_16x16x32_bf16 v[100:103], v[32:35], v[224:227], v[100:103]
    v_mfma_f32_16x16x32_bf16 v[96:99], v[36:39], v[224:227], v[96:99]
    v_mfma_f32_16x16x32_bf16 v[92:95], v[64:67], v[236:239], v[92:95]
    v_mfma_f32_16x16x32_bf16 v[92:95], v[52:55], v[220:223], v[92:95]
    v_mfma_f32_16x16x32_bf16 v[92:95], v[40:43], v[224:227], v[92:95]
    s_nop 3
    v_cvt_pk_bf16_f32 v100, v100, v101
    v_cvt_pk_bf16_f32 v96, v96, v97
    v_cvt_pk_bf16_f32 v97, v98, v99
    ds_write_b64 v12, v[96:97] offset:50464
    v_cvt_pk_bf16_f32 v92, v92, v93
    v_cvt_pk_bf16_f32 v93, v94, v95
    v_cvt_pk_bf16_f32 v101, v102, v103
    ds_write_b64 v12, v[92:93] offset:50432
    ds_write_b64 v12, v[100:101] offset:50496
    s_waitcnt lgkmcnt(0)
    s_barrier
    ds_read_b128 v[180:183], v13 offset:37632
    ds_read_b128 v[184:187], v13 offset:37760
    ds_read_b128 v[188:191], v13 offset:37888
    ds_read_b128 v[192:195], v13 offset:38032
    ds_read_b128 v[172:175], v13 offset:38160
    ds_read_b128 v[176:179], v13 offset:38288
    s_waitcnt lgkmcnt(5)
    buffer_store_dwordx4 v[180:183], v14, s[40:43], s91 offen offset:0 sc1
    s_waitcnt lgkmcnt(4)
    buffer_store_dwordx4 v[184:187], v14, s[40:43], s91 offen offset:128 sc1
    s_waitcnt lgkmcnt(3)
    buffer_store_dwordx4 v[188:191], v14, s[40:43], s91 offen offset:256 sc1
    s_waitcnt lgkmcnt(2)
    buffer_store_dwordx4 v[192:195], v15, s[40:43], s91 offen offset:384 sc1
    s_waitcnt lgkmcnt(1)
    buffer_store_dwordx4 v[172:175], v15, s[40:43], s91 offen offset:512 sc1
    s_waitcnt lgkmcnt(0)
    buffer_store_dwordx4 v[176:179], v15, s[40:43], s91 offen offset:640 sc1

L_end:
    s_endpgm
.section .rodata,"a"
.p2align 6
.amdhsa_kernel standalone__window_attn_davit__vision_kernel
  .amdhsa_next_free_vgpr 512
  .amdhsa_next_free_sgpr 102
  .amdhsa_accum_offset 256
  .amdhsa_group_segment_fixed_size 0
  .amdhsa_kernarg_size 56
  .amdhsa_user_sgpr_count 2
  .amdhsa_user_sgpr_kernarg_segment_ptr 1
  .amdhsa_system_sgpr_workgroup_id_x 1
.end_amdhsa_kernel
```
